```python
import torch

def _softmax(x, axis=-1):
    return torch.softmax(x, dim=axis)
def _gelu(x):
    return torch.nn.functional.gelu(x, approximate="tanh")
def _silu(x):
    return torch.nn.functional.silu(x)
def _sigmoid(x):
    return torch.sigmoid(x)
def _layernorm(x, axis=-1, eps=1e-5):
    m = x.mean(dim=axis, keepdim=True)
    v = x.var(dim=axis, keepdim=True, unbiased=False)
    return (x - m) / torch.sqrt(v + eps)
def _scatter_add(tgt, idx, src, axis=0):
    return tgt.clone().index_add_(axis, idx, src)
def _segment_sum(src, seg, n):
    out = torch.zeros((n,) + src.shape[1:], dtype=src.dtype)
    return out.index_add_(0, seg, src)
def _pad(x, pw):
    flat = tuple(v for pair in reversed(pw) for v in pair)
    return torch.nn.functional.pad(x, flat)

kernel_name = 'sequential_preLN__grouped_kv_mqa__geglu_ffn__prompt'

def setup_inputs():

    _w = (lambda a: (lambda t: t.to(torch.bfloat16) if t.is_floating_point() else t)(torch.as_tensor(a)))
    def _A_setup():
        B, S, D, H = 1, 2048, 512, 32
        Dh = D // H
        return {
            "x": _w((lambda *s: torch.randn(*s, dtype=torch.bfloat16) * 0.05)(B, S, D)),
            "wq": _w((lambda *s: torch.randn(*s, dtype=torch.bfloat16) * 0.05)(D, H * Dh)),
            "wk": _w((lambda *s: torch.randn(*s, dtype=torch.bfloat16) * 0.05)(D, Dh)),
            "wv": _w((lambda *s: torch.randn(*s, dtype=torch.bfloat16) * 0.05)(D, Dh)),
            "wo": _w((lambda *s: torch.randn(*s, dtype=torch.bfloat16) * 0.05)(H * Dh, D)),
        }
    _A_in = _A_setup()

    def _B_setup():
        B, S, D, F = 1, 2048, 512, 1792
        return {
            "x": _w((lambda *s: torch.randn(*s, dtype=torch.bfloat16) * 0.05)(B, S, D)),
            "w_gate": _w((lambda *s: torch.randn(*s, dtype=torch.bfloat16) * 0.05)(D, F)),
            "w_up": _w((lambda *s: torch.randn(*s, dtype=torch.bfloat16) * 0.05)(D, F)),
            "w_down": _w((lambda *s: torch.randn(*s, dtype=torch.bfloat16) * 0.05)(F, D)),
        }
    _B_in = _B_setup()

    return {
        "A_x": _A_in["x"],
        "A_wq": _A_in["wq"],
        "A_wk": _A_in["wk"],
        "A_wv": _A_in["wv"],
        "A_wo": _A_in["wo"],
        "B_x": _B_in["x"],
        "B_w_gate": _B_in["w_gate"],
        "B_w_up": _B_in["w_up"],
        "B_w_down": _B_in["w_down"],
    }

def reference(A_x, A_wq, A_wk, A_wv, A_wo, B_x, B_w_gate, B_w_up, B_w_down):
    def _A_ref(x, wq, wk, wv, wo):
        B, S, D = x.shape
        H = 32
        Dh = D // H
        q = (lambda x, *d: x.permute(*d))((x @ wq).reshape(B, S, H, Dh), 0, 2, 1, 3)
        k = x @ wk
        v = x @ wv
        scores = torch.einsum("bhqd,bkd->bhqk", q, k) * (Dh ** -0.5)
        p = _softmax(scores, axis=-1)
        o = torch.einsum("bhqk,bkd->bhqd", p, v)
        return (lambda x, *d: x.permute(*d))(o, 0, 2, 1, 3).reshape(B, S, H * Dh) @ wo

    def _B_ref(x, w_gate, w_up, w_down):
        return (_gelu(x @ w_gate) * (x @ w_up)) @ w_down

    x = A_x
    h = x + _A_ref(_layernorm(x, axis=-1), A_wq, A_wk, A_wv, A_wo)
    h2 = h + _B_ref(_layernorm(h, axis=-1), B_w_gate, B_w_up, B_w_down)
    return h2
```

```asm
; @launch grid=(256,1,1) block=(512,1,1) lds=163840
.amdgcn_target "amdgcn-amd-amdhsa--gfx950"
.text
.globl sequential_preLN__grouped_kv_mqa__geglu_ffn__prompt_kernel
.p2align 8
.type sequential_preLN__grouped_kv_mqa__geglu_ffn__prompt_kernel,@function
sequential_preLN__grouped_kv_mqa__geglu_ffn__prompt_kernel:
L_start:
  s_cmp_ge_u32 s2, 256
  s_cbranch_scc1 L_exit
  s_load_dwordx16 s[72:87], s[0:1], 0
  s_load_dwordx8 s[88:95], s[0:1], 64
  s_getpc_b64 s[68:69]
  v_lshrrev_b32 v2, 6, v0
  s_lshr_b32 s3, s2, 3
  v_and_b32 v0, 63, v0
  v_readfirstlane_b32 s44, v2
  v_lshl_add_u32 v2, s3, 3, v2
  v_and_b32 v3, 1, v0
  v_lshl_add_u32 v2, v2, 1, v3
  v_lshlrev_b32 v2, 7, v2
  v_min_u32 v2, L_end-L_start-256, v2
  global_load_dword v30, v2, s[68:69]
  v_lshlrev_b32 v1, 4, v0
  s_and_b32 s54, s2, 7
  s_lshl_b32 s54, s54, 3
  s_lshr_b32 s55, s3, 3
  s_lshl_b32 s55, s55, 1
  s_add_u32 s51, s54, s55
  s_lshl_b32 s50, s51, 5
  s_and_b32 s48, s3, 7
  s_and_b32 s52, s3, 1
  s_mov_b32 s10, 0x200000
  s_mov_b32 s11, 0x20000
  s_mov_b32 s42, 0x12c0000
  s_mov_b32 s43, 0x20000
  s_mov_b32 s14, 0x80000
  s_mov_b32 s15, 0x20000
  s_mov_b32 s18, 16384
  s_mov_b32 s19, 0x20000
  v_and_b32 v48, 15, v0
  v_lshrrev_b32 v49, 4, v0
  s_lshr_b32 s55, s48, 1
  s_lshl_b32 s54, s55, 4
  s_add_u32 s54, s54, s50
  s_lshl_b32 s54, s54, 10
  s_lshl_b32 s56, s44, 8
  s_add_u32 s54, s54, s56
  v_lshlrev_b32 v3, 10, v48
  v_lshl_add_u32 v3, v49, 4, v3
  s_lshl_b32 s56, s44, 12
  s_mov_b32 m0, s56
  s_cmp_eq_u32 s52, 0
  s_waitcnt lgkmcnt(0)
  s_mov_b64 s[8:9], s[72:73]
  s_cselect_b64 s[16:17], s[76:77], s[78:79]
  s_mov_b64 s[40:41], s[94:95]
  s_mov_b64 s[12:13], s[74:75]
  s_cmp_ge_u32 s44, 4
  s_cbranch_scc1 L_b0
  buffer_load_dwordx4 v1, s[16:19], s56 offen offset:0 lds
  buffer_load_dwordx4 v1, s[16:19], s56 offen offset:1024 lds
  buffer_load_dwordx4 v1, s[16:19], s56 offen offset:2048 lds
  buffer_load_dwordx4 v1, s[16:19], s56 offen offset:3072 lds
  buffer_load_dwordx4 v[32:35], v3, s[8:11], s54 offen offset:0
  buffer_load_dwordx4 v[36:39], v3, s[8:11], s54 offen offset:64
  buffer_load_dwordx4 v[40:43], v3, s[8:11], s54 offen offset:128
  buffer_load_dwordx4 v[44:47], v3, s[8:11], s54 offen offset:192
  v_mov_b32 v120, 163332
  v_mov_b32 v121, 0
  ds_write_b32 v120, v121
  s_waitcnt lgkmcnt(0)
  s_barrier
  s_branch L_c0
L_b0:
  s_lshl_b32 s57, s3, 14
  s_add_u32 s57, s57, s56
  s_sub_u32 s57, s57, 16384
  v_and_b32 v2, 31, v0
  v_lshlrev_b32 v2, 7, v2
  s_and_b32 s54, s2, 7
  s_lshl_b32 s54, s54, 5
  s_add_u32 s54, s54, s3
  s_lshl_b32 s55, s54, 8
  s_lshl_b32 s58, s44, 16
  s_add_u32 s55, s55, s58
  s_add_u32 s55, s55, 1310720
  s_lshl_b32 s58, s54, 6
  s_add_u32 s58, s58, 1769472
  s_cmp_eq_u32 s44, 6
  s_cselect_b32 s55, s58, s55
  s_lshl_b32 s58, s54, 5
  s_add_u32 s58, s58, 28672
  s_cmp_eq_u32 s44, 7
  s_cselect_b32 s55, s58, s55
  s_barrier
  s_mov_b64 exec, 3
  buffer_load_dword v29, v2, s[40:43], s55 offen
  s_mov_b64 exec, -1
  buffer_load_dword v29, v2, s[12:15], s57 offen
L_c0:
  buffer_load_dword v31, off, s[40:43], 0 sc1
  s_mov_b32 s60, 0x3f803f80
  s_mov_b32 s61, 0xffff0000
  s_mov_b32 s21, 0
  s_mov_b32 s77, s44
  s_add_u32 s44, s44, 4
  s_and_b32 s44, s44, 7
  s_and_b32 s4, s44, 1
  s_lshr_b32 s5, s44, 1
  s_lshr_b32 s45, s51, 2
  s_and_b32 s46, s3, 15
  s_lshr_b32 s47, s46, 3
  s_lshl_b32 s53, s45, 4
  s_add_u32 s53, s53, s46
  s_mov_b64 s[36:37], s[90:91]
  s_mov_b32 s38, 0x200000
  s_mov_b32 s39, 0x20000
  s_mov_b64 s[24:25], s[84:85]
  s_mov_b32 s26, 0x1c0000
  s_mov_b32 s27, 0x20000
  s_mov_b64 s[28:29], s[86:87]
  s_mov_b32 s30, 0x1c0000
  s_mov_b32 s31, 0x20000
  s_mov_b32 s35, 0x20000
  s_lshl_b32 s63, s44, 12
  s_add_u32 s63, s63, 133120
  s_lshl_b32 s96, s44, 5
  s_add_u32 s96, s96, s3
  s_and_b32 s79, s2, 7
  s_and_b32 s97, s96, 3
  s_lshl_b32 s98, s79, 2
  s_add_u32 s97, s97, s98
  s_lshr_b32 s98, s96, 2
  s_mul_i32 s72, s97, 57344
  s_lshl_b32 s100, s98, 7
  s_add_u32 s72, s72, s100
  s_add_u32 s100, s100, s97
  s_lshl_b32 s100, s100, 10
  s_add_u32 s73, s100, 13631488
  s_cmp_lt_u32 s96, 112
  s_cselect_b32 s74, s63, 163840
  s_cselect_b32 s73, s73, 0x40000000
  s_sub_u32 s96, s96, 128
  s_mov_b32 s34, 0x80000
  s_mov_b32 s99, 19136512
  s_cmp_lt_u32 s96, 56
  s_cselect_b64 s[32:33], s[88:89], s[80:81]
  s_cselect_b32 s34, 0x1c0000, s34
  s_cselect_b32 s97, 0, 56
  s_cselect_b32 s98, 112, 32
  s_cselect_b32 s23, 14, 4
  s_cselect_b32 s99, 17301504, s99
  s_sub_u32 s97, s96, s97
  s_and_b32 s100, s97, 3
  s_lshr_b32 s97, s97, 2
  s_mul_i32 s23, s23, s79
  s_add_u32 s97, s97, s23
  s_lshl_b32 s75, s97, 14
  s_lshl_b32 s23, s100, 8
  s_add_u32 s75, s75, s23
  s_lshl_b32 s82, s98, 11
  s_mul_i32 s100, s100, s98
  s_lshl_b32 s100, s100, 1
  s_add_u32 s100, s100, s97
  s_lshl_b32 s100, s100, 11
  s_add_u32 s76, s100, s99
  s_cmp_lt_u32 s96, 72
  s_cselect_b32 s78, s63, 163840
  s_cselect_b32 s76, s76, 0x40000000
  s_cselect_b32 s75, s75, 0
  s_cmp_lt_u32 s44, 4
  s_cselect_b32 s76, s73, s76
  s_cselect_b32 s82, 0x10000, s82
  s_movk_i32 s73, 1024
  s_cselect_b32 s73, 0x8000, s73
  v_lshrrev_b32 v12, 2, v0
  v_mul_u32_u24 v12, 3584, v12
  v_and_b32 v50, 3, v0
  v_lshl_add_u32 v12, v50, 4, v12
  v_mov_b32 v8, s60
  v_mov_b32 v9, s60
  v_mov_b32 v10, s60
  v_mov_b32 v11, s60
  v_mul_u32_u24 v19, 1056, v48
  v_lshl_add_u32 v19, v49, 4, v19
  s_mul_i32 s98, s4, 33792
  s_add_u32 s98, s98, 29696
  v_add_u32 v19, s98, v19
  v_lshrrev_b32 v28, 2, v48
  v_lshl_add_u32 v28, v49, 3, v28
  v_lshlrev_b32 v28, 7, v28
  v_lshrrev_b32 v14, 3, v48
  v_and_b32 v15, 1, v49
  v_lshl_or_b32 v14, v15, 1, v14
  v_xor_b32 v14, s5, v14
  v_lshl_add_u32 v28, v14, 5, v28
  v_lshl_add_u32 v28, v50, 3, v28
  v_add_u32 v28, 97280, v28
  v_lshlrev_b32 v14, 3, v48
  s_lshl_b32 s79, s79, 3
  s_add_u32 s79, s79, s44
  v_lshrrev_b32 v15, 2, v0
  v_lshl_add_u32 v15, v15, 3, s79
  v_and_b32 v15, 63, v15
  v_lshlrev_b32 v15, 7, v15
  v_lshlrev_b32 v13, 3, v50
  v_add_u32 v126, v13, v15
  s_add_u32 s98, s51, s4
  s_lshl_b32 s23, s98, 8
  s_add_u32 s23, s23, 1245184
  s_sub_u32 s98, s98, s79
  s_lshl_b32 s98, s98, 7
  v_bfe_u32 v15, v0, 2, 1
  v_mul_lo_u32 v15, v15, s98
  s_lshl_b32 s98, s79, 7
  v_add3_u32 v15, v15, v13, s98
  v_bfe_u32 v50, v0, 3, 1
  v_xor_b32 v50, 1, v50
  v_mul_u32_u24 v50, 24576, v50
  v_add_u32 v15, v15, v50
  s_mov_b32 s100, 0
  s_mov_b32 s20, 4096
  v_and_b32 v51, 31, v0
  v_lshrrev_b32 v52, 5, v0
  v_lshlrev_b32 v3, 8, v52
  v_lshl_add_u32 v3, v51, 4, v3
  v_add_u32 v3, 1024, v3
  v_mov_b32 v53, 0x100000
  v_cmp_gt_u32 vcc, 16, v51
  s_lshl_b32 s67, s53, 7
  s_lshl_b32 s97, s44, 2
  v_cndmask_b32 v3, v53, v3, vcc
  v_add_u32 v4, 512, v3
  v_mov_b32 v53, 2048
  s_mov_b32 vcc_lo, 0x10010000
  s_mov_b32 vcc_hi, 0x10010000
  s_add_u32 s67, s67, s97
  s_add_u32 s67, s67, 65536
  v_cndmask_b32 v3, v3, v53, vcc
  v_cndmask_b32 v4, v4, v53, vcc
  v_mov_b32 v125, v1
  s_add_u32 s97, s97, 163392
  v_mov_b32 v16, s97
  v_mul_u32_u24 v17, 2064, v0
  v_add_u32 v17, 2048, v17
  v_bfe_u32 v6, v0, 2, 2
  v_lshlrev_b32 v6, 6, v6
  v_lshl_add_u32 v6, v52, 8, v6
  v_bfe_u32 v53, v0, 4, 1
  v_lshl_add_u32 v6, v53, 11, v6
  v_add3_u32 v6, v6, v13, s63
  v_lshrrev_b32 v124, 2, v0
  v_lshlrev_b32 v124, 10, v124
  v_bfe_u32 v53, v0, 1, 1
  v_lshl_add_u32 v124, v53, 6, v124
  v_and_b32 v53, 1, v0
  v_lshl_add_u32 v124, v53, 4, v124
  s_mul_i32 s96, s45, 458752
  s_mul_i32 s97, s46, 7
  s_min_u32 s98, s44, 6
  s_add_u32 s97, s97, s98
  s_lshl_b32 s65, s97, 15
  s_add_u32 s65, s65, 13631488
  s_lshl_b32 s97, s97, 10
  s_add_u32 s7, s96, s97
  s_add_u32 s7, s7, 6291456
  s_mul_i32 s96, s48, 112
  s_mul_i32 s97, s44, 14
  s_add_u32 s96, s96, s97
  s_lshl_b32 s96, s96, 11
  s_add_u32 s66, s96, 17301504
  s_lshl_b32 s83, s44, 12
  s_cmp_eq_u32 s44, 7
  s_cselect_b32 s65, 0x40000000, s65
  s_lshl_b32 s97, s48, 2
  s_add_u32 s97, s97, s5
  s_lshl_b32 s97, s97, 10
  s_lshl_b32 s6, s48, 16
  s_lshl_b32 s22, s44, 13
  s_add_u32 s6, s6, s22
  s_add_u32 s6, s6, 19136512
  v_and_b32 v2, 0xf0, v1
  v_and_b32 v53, 1, v49
  v_lshl_add_u32 v2, v53, 9, v2
  v_lshl_add_u32 v2, v52, 11, v2
  v_lshlrev_b32 v7, 7, v0
  s_add_u32 s96, s51, s4
  s_lshl_b32 s98, s96, 15
  s_add_u32 s97, s97, s98
  s_add_u32 s97, s97, 2097152
  v_and_b32 v51, 7, v0
  v_lshlrev_b32 v18, 2, v51
  v_add_u32 v18, 163392, v18
  v_lshlrev_b32 v51, 7, v51
  v_lshrrev_b32 v52, 3, v0
  v_lshl_add_u32 v5, v52, 21, v51
  v_add_u32 v5, s97, v5
  s_bfe_u32 s96, s44, 0x10001
  s_add_u32 s96, s96, s51
  s_lshl_b32 s96, s96, 12
  s_lshl_b32 s97, s48, 9
  s_add_u32 s96, s96, s97
  s_lshr_b32 s97, s44, 2
  s_lshl_b32 s97, s97, 8
  s_add_u32 s96, s96, s97
  s_lshl_b32 s97, s4, 7
  v_lshlrev_b32 v53, 8, v51
  v_add_u32 v53, s67, v53
  v_cmp_gt_u32 vcc, 16, v0
  s_add_u32 s96, s96, s97
  s_add_u32 s62, s96, 1310720
  v_cndmask_b32 v5, v53, v5, vcc
  v_mov_b32 v53, s62
  v_cmp_gt_u32 vcc, 22, v0
  s_and_b32 s96, s2, 7
  s_lshl_b32 s97, s3, 3
  v_cndmask_b32 v5, v53, v5, vcc
  s_add_u32 s97, s97, s44
  s_lshl_b32 s98, s96, 8
  s_add_u32 s97, s97, s98
  s_mul_i32 s96, s97, 896
  s_lshl_b32 s97, s97, 8
  s_add_u32 s84, s84, s96
  s_addc_u32 s85, s85, 0
  s_add_u32 s86, s86, s96
  s_addc_u32 s87, s87, 0
  s_add_u32 s88, s88, s96
  s_addc_u32 s89, s89, 0
  s_add_u32 s80, s80, s97
  s_addc_u32 s81, s81, 0
  s_cmp_ge_u32 s77, 4
  s_cbranch_scc1 L_bulk
  s_setprio 3
  v_mov_b32 v56, 0
  v_mov_b32 v57, 0
  v_mov_b32 v58, 0
  v_mov_b32 v59, 0
  v_lshlrev_b32 v20, 8, v49
  v_lshl_add_u32 v20, v48, 3, v20
  v_add_u32 v20, s56, v20
  v_add_u32 v21, s56, v1
  s_cmp_eq_u32 s52, 0
  s_cselect_b32 s57, 0, 8
  v_lshlrev_b32 v22, 3, v48
  v_lshlrev_b32 v24, 5, v49
  s_cselect_b64 vcc, -1, 0
  v_cndmask_b32 v23, v24, v22, vcc
  v_add_u32 v22, s56, v22
  v_add_u32 v24, s57, v23
  v_add_u32 v25, s57, v24
  v_add_u32 v26, s57, v25
  v_lshrrev_b32 v51, 1, v49
  v_and_b32 v52, 1, v49
  v_lshlrev_b32 v27, 9, v51
  v_lshl_add_u32 v27, v52, 3, v27
  v_lshlrev_b32 v53, 8, v51
  v_lshl_add_u32 v53, v52, 3, v53
  v_cndmask_b32 v27, v53, v27, vcc
  v_lshl_add_u32 v27, v48, 4, v27
  v_mov_b32 v121, 1
  v_mul_u32_u24 v60, 1056, v48
  v_lshl_add_u32 v60, v49, 4, v60
  s_mul_i32 s57, s55, 16896
  s_lshl_b32 s58, s77, 8
  s_add_u32 s57, s57, s58
  s_add_u32 s57, s57, 29696
  v_add_u32 v60, s57, v60
  s_lshl_b32 s56, s51, 1
  s_add_u32 s56, s56, s55
  s_lshl_b32 s57, s56, 9
  s_add_u32 s57, s57, 1114112
  s_lshr_b32 s54, s56, 1
  s_lshl_b32 s59, s54, 7
  s_lshl_b32 s54, s54, 10
  s_and_b32 s58, s56, 1
  s_lshl_b32 s58, s58, 8
  s_add_u32 s54, s54, s58
  s_add_u32 s54, s54, 1048576
  s_and_b32 s58, s48, 3
  s_lshl_b32 s58, s58, 3
  s_add_u32 s59, s59, s58
  s_add_u32 s59, s59, 4096
  s_getreg_b32 s58, hwreg(HW_REG_XCC_ID)
  s_lshl_b32 s55, s56, 7
  s_add_u32 s55, s55, 1245184
  s_cmp_eq_u32 s52, 0
  s_cselect_b32 s54, s54, s57
  s_cselect_b32 s55, s55, 0x40000000
  s_add_u32 s96, s54, 524288
  s_add_u32 s97, s55, 524288
  s_add_u32 s98, s59, 24576
  s_cmp_eq_u32 s52, 0
  s_waitcnt vmcnt(5)
  ds_read_b64_tr_b16 v[96:97], v20 offset:0
  ds_read_b64_tr_b16 v[98:99], v20 offset:128
  ds_read_b64_tr_b16 v[100:101], v20 offset:1024
  ds_read_b64_tr_b16 v[102:103], v20 offset:1152
  ds_read_b64_tr_b16 v[104:105], v20 offset:2048
  ds_read_b64_tr_b16 v[106:107], v20 offset:2176
  ds_read_b64_tr_b16 v[108:109], v20 offset:3072
  ds_read_b64_tr_b16 v[110:111], v20 offset:3200
  s_waitcnt vmcnt(4)
  v_dot2c_f32_bf16 v56, v32, v8
  v_dot2c_f32_bf16 v58, v32, v32
  v_dot2c_f32_bf16 v57, v33, v8
  v_dot2c_f32_bf16 v59, v33, v33
  v_dot2c_f32_bf16 v56, v34, v8
  v_dot2c_f32_bf16 v58, v34, v34
  v_dot2c_f32_bf16 v57, v35, v8
  v_dot2c_f32_bf16 v59, v35, v35
  s_waitcnt vmcnt(3)
  v_dot2c_f32_bf16 v56, v36, v8
  v_dot2c_f32_bf16 v58, v36, v36
  v_dot2c_f32_bf16 v57, v37, v8
  v_dot2c_f32_bf16 v59, v37, v37
  v_dot2c_f32_bf16 v56, v38, v8
  v_dot2c_f32_bf16 v58, v38, v38
  v_dot2c_f32_bf16 v57, v39, v8
  v_dot2c_f32_bf16 v59, v39, v39
  s_waitcnt vmcnt(2)
  v_dot2c_f32_bf16 v56, v40, v8
  v_dot2c_f32_bf16 v58, v40, v40
  v_dot2c_f32_bf16 v57, v41, v8
  v_dot2c_f32_bf16 v59, v41, v41
  v_dot2c_f32_bf16 v56, v42, v8
  v_dot2c_f32_bf16 v58, v42, v42
  v_dot2c_f32_bf16 v57, v43, v8
  v_dot2c_f32_bf16 v59, v43, v43
  s_waitcnt vmcnt(1)
  v_dot2c_f32_bf16 v56, v44, v8
  v_dot2c_f32_bf16 v58, v44, v44
  v_dot2c_f32_bf16 v57, v45, v8
  v_dot2c_f32_bf16 v59, v45, v45
  v_dot2c_f32_bf16 v56, v46, v8
  v_dot2c_f32_bf16 v58, v46, v46
  v_dot2c_f32_bf16 v57, v47, v8
  v_dot2c_f32_bf16 v59, v47, v47
  s_waitcnt lgkmcnt(0)
  s_cbranch_scc0 L_kv_v
  v_mfma_f32_16x16x32_bf16 v[112:115], v[96:99], v[32:35], 0
  v_mfma_f32_16x16x32_bf16 v[116:119], v[96:99], v[8:11], 0
  v_mfma_f32_16x16x32_bf16 v[112:115], v[100:103], v[36:39], v[112:115]
  v_mfma_f32_16x16x32_bf16 v[116:119], v[100:103], v[8:11], v[116:119]
  v_mfma_f32_16x16x32_bf16 v[112:115], v[104:107], v[40:43], v[112:115]
  v_mfma_f32_16x16x32_bf16 v[116:119], v[104:107], v[8:11], v[116:119]
  v_mfma_f32_16x16x32_bf16 v[112:115], v[108:111], v[44:47], v[112:115]
  v_mfma_f32_16x16x32_bf16 v[116:119], v[108:111], v[8:11], v[116:119]
  s_branch L_kv_e
L_kv_v:
  v_mfma_f32_16x16x32_bf16 v[112:115], v[32:35], v[96:99], 0
  v_mfma_f32_16x16x32_bf16 v[116:119], v[8:11], v[96:99], 0
  v_mfma_f32_16x16x32_bf16 v[112:115], v[36:39], v[100:103], v[112:115]
  v_mfma_f32_16x16x32_bf16 v[116:119], v[8:11], v[100:103], v[116:119]
  v_mfma_f32_16x16x32_bf16 v[112:115], v[40:43], v[104:107], v[112:115]
  v_mfma_f32_16x16x32_bf16 v[116:119], v[8:11], v[104:107], v[116:119]
  v_mfma_f32_16x16x32_bf16 v[112:115], v[44:47], v[108:111], v[112:115]
  v_mfma_f32_16x16x32_bf16 v[116:119], v[8:11], v[108:111], v[116:119]
L_kv_e:
  v_add_f32 v56, v56, v57
  v_add_f32 v57, v58, v59
  v_mov_b32 v58, v56
  v_mov_b32 v59, v57
  s_nop 0
  v_permlane16_swap_b32 v56, v58
  v_permlane16_swap_b32 v57, v59
  v_add_f32 v56, v56, v58
  v_add_f32 v57, v57, v59
  v_mov_b32 v58, v56
  v_mov_b32 v59, v57
  s_nop 0
  v_permlane32_swap_b32 v56, v58
  v_permlane32_swap_b32 v57, v59
  v_add_f32 v56, v56, v58
  v_add_f32 v57, v57, v59
  ds_write_b64 v22, v[56:57] offset:2048
  ds_write_b128 v21, v[112:115]
  ds_write_b128 v21, v[116:119] offset:1024
  s_mov_b64 exec, 1
  ds_add_rtn_u32 v122, v120, v121
  s_mov_b64 exec, -1
  ds_write_b128 v60, v[32:35] offset:0
  ds_write_b128 v60, v[36:39] offset:64
  ds_write_b128 v60, v[40:43] offset:128
  ds_write_b128 v60, v[44:47] offset:192
  s_waitcnt vmcnt(0)
  v_readfirstlane_b32 s49, v31
  s_nop 0
  s_mul_i32 s49, s49, 0x9E3779B1
  s_add_u32 s49, s49, 0x7F4A7C15
  s_waitcnt lgkmcnt(4)
  v_readfirstlane_b32 s56, v122
  s_nop 0
  s_cmp_lg_u32 s56, 3
  s_cbranch_scc1 L_kv_done
  ds_read_b64 v[64:65], v23 offset:2048
  ds_read_b64 v[66:67], v24 offset:2048
  ds_read_b64 v[68:69], v25 offset:2048
  ds_read_b64 v[70:71], v26 offset:2048
  ds_read_b64 v[72:73], v23 offset:6144
  ds_read_b64 v[74:75], v24 offset:6144
  ds_read_b64 v[76:77], v25 offset:6144
  ds_read_b64 v[78:79], v26 offset:6144
  ds_read_b64 v[80:81], v23 offset:10240
  ds_read_b64 v[82:83], v24 offset:10240
  ds_read_b64 v[84:85], v25 offset:10240
  ds_read_b64 v[86:87], v26 offset:10240
  ds_read_b64 v[88:89], v23 offset:14336
  ds_read_b64 v[90:91], v24 offset:14336
  ds_read_b64 v[92:93], v25 offset:14336
  ds_read_b64 v[94:95], v26 offset:14336
  ds_read_b128 v[32:35], v1 offset:0
  ds_read_b128 v[36:39], v1 offset:1024
  ds_read_b128 v[40:43], v1 offset:4096
  ds_read_b128 v[44:47], v1 offset:5120
  ds_read_b128 v[48:51], v1 offset:8192
  ds_read_b128 v[52:55], v1 offset:9216
  ds_read_b128 v[56:59], v1 offset:12288
  ds_read_b128 v[60:63], v1 offset:13312
  s_waitcnt lgkmcnt(15)
  v_pk_add_f32 v[64:65], v[64:65], v[72:73]
  v_pk_add_f32 v[66:67], v[66:67], v[74:75]
  v_pk_add_f32 v[68:69], v[68:69], v[76:77]
  v_pk_add_f32 v[70:71], v[70:71], v[78:79]
  s_waitcnt lgkmcnt(12)
  v_pk_add_f32 v[64:65], v[64:65], v[80:81]
  v_pk_add_f32 v[66:67], v[66:67], v[82:83]
  v_pk_add_f32 v[68:69], v[68:69], v[84:85]
  v_pk_add_f32 v[70:71], v[70:71], v[86:87]
  s_waitcnt lgkmcnt(8)
  v_pk_add_f32 v[64:65], v[64:65], v[88:89]
  v_pk_add_f32 v[66:67], v[66:67], v[90:91]
  v_pk_add_f32 v[68:69], v[68:69], v[92:93]
  v_pk_add_f32 v[70:71], v[70:71], v[94:95]
  v_mul_f32 v64, 0x3b000000, v64
  v_mul_f32 v65, 0x3b000000, v65
  v_fma_f32 v65, -v64, v64, v65
  v_max_f32 v65, 0, v65
  v_add_f32 v65, 0x3727c5ac, v65
  v_rsq_f32 v65, v65
  v_mul_f32 v66, 0x3b000000, v66
  v_mul_f32 v67, 0x3b000000, v67
  v_fma_f32 v67, -v66, v66, v67
  v_max_f32 v67, 0, v67
  v_add_f32 v67, 0x3727c5ac, v67
  v_rsq_f32 v67, v67
  v_mul_f32 v68, 0x3b000000, v68
  v_mul_f32 v69, 0x3b000000, v69
  v_fma_f32 v69, -v68, v68, v69
  v_max_f32 v69, 0, v69
  v_add_f32 v69, 0x3727c5ac, v69
  v_rsq_f32 v69, v69
  v_mul_f32 v70, 0x3b000000, v70
  v_mul_f32 v71, 0x3b000000, v71
  v_fma_f32 v71, -v70, v70, v71
  v_max_f32 v71, 0, v71
  v_add_f32 v71, 0x3727c5ac, v71
  v_rsq_f32 v71, v71
  s_waitcnt lgkmcnt(4)
  v_pk_add_f32 v[32:33], v[32:33], v[40:41]
  v_pk_add_f32 v[34:35], v[34:35], v[42:43]
  v_pk_add_f32 v[36:37], v[36:37], v[44:45]
  v_pk_add_f32 v[38:39], v[38:39], v[46:47]
  s_waitcnt lgkmcnt(2)
  v_pk_add_f32 v[32:33], v[32:33], v[48:49]
  v_pk_add_f32 v[34:35], v[34:35], v[50:51]
  v_pk_add_f32 v[36:37], v[36:37], v[52:53]
  v_pk_add_f32 v[38:39], v[38:39], v[54:55]
  s_waitcnt lgkmcnt(0)
  v_pk_add_f32 v[32:33], v[32:33], v[56:57]
  v_pk_add_f32 v[34:35], v[34:35], v[58:59]
  v_pk_add_f32 v[36:37], v[36:37], v[60:61]
  v_pk_add_f32 v[38:39], v[38:39], v[62:63]
  v_fma_f32 v32, -v64, v36, v32
  v_fma_f32 v33, -v66, v37, v33
  v_fma_f32 v34, -v68, v38, v34
  v_fma_f32 v35, -v70, v39, v35
  v_mul_f32 v32, v32, v65
  v_mul_f32 v33, v33, v67
  v_mul_f32 v34, v34, v69
  v_mul_f32 v35, v35, v71
  v_cvt_pk_bf16_f32 v32, v32, v33
  v_cvt_pk_bf16_f32 v33, v34, v35
  buffer_store_dwordx2 v[32:33], v27, s[40:43], s96 offen
  s_mov_b64 exec, 0xffff
  buffer_store_dwordx2 v[64:65], v14, s[40:43], s97 offen
  buffer_store_dwordx2 v[64:65], v14, s[40:43], s55 offen sc1
  s_mov_b64 exec, -1
  buffer_store_dwordx2 v[32:33], v27, s[40:43], s54 offen sc1
  v_mov_b32 v20, s49
  v_mov_b32 v21, s58
  s_mov_b32 s100, 1
  s_mov_b32 s101, s59
  s_mov_b64 exec, 1
  s_waitcnt vmcnt(2)
  buffer_store_dwordx2 v[20:21], off, s[40:43], s98
  s_mov_b64 exec, -1
L_kv_done:
L_kv_d2:
  s_setprio 0
  s_waitcnt lgkmcnt(0)
  s_branch L_p1j
L_bulk:
  v_lshrrev_b32 v24, 3, v0
  v_and_b32 v22, 7, v0
  v_and_b32 v21, 2, v24
  v_xor_b32 v21, v22, v21
  v_lshlrev_b32 v20, 10, v24
  v_lshl_add_u32 v20, v21, 4, v20
  v_xor_b32 v21, 64, v20
  s_lshr_b32 s54, s48, 1
  s_lshl_b32 s57, s44, 2
  s_add_u32 s58, s54, 1
  s_and_b32 s58, s58, 3
  s_lshl_b32 s58, s58, 4
  s_add_u32 s58, s58, s57
  s_add_u32 s55, s50, s58
  s_lshl_b32 s55, s55, 10
  s_mul_i32 s56, s58, 1056
  s_add_u32 m0, s56, 29696
  s_nop 0
  buffer_load_dwordx4 v1, s[8:11], s55 offen lds
  s_add_u32 m0, m0, 1056
  s_add_u32 s55, s55, 1024
  buffer_load_dwordx4 v1, s[8:11], s55 offen lds
  s_add_u32 m0, m0, 1056
  s_add_u32 s55, s55, 1024
  buffer_load_dwordx4 v1, s[8:11], s55 offen lds
  s_add_u32 m0, m0, 1056
  s_add_u32 s55, s55, 1024
  buffer_load_dwordx4 v1, s[8:11], s55 offen lds
  s_add_u32 s58, s54, 2
  s_and_b32 s58, s58, 3
  s_lshl_b32 s58, s58, 4
  s_add_u32 s58, s58, s57
  s_add_u32 s55, s50, s58
  s_lshl_b32 s55, s55, 10
  s_mul_i32 s56, s58, 1056
  s_add_u32 m0, s56, 29696
  s_nop 0
  buffer_load_dwordx4 v1, s[8:11], s55 offen lds
  s_add_u32 m0, m0, 1056
  s_add_u32 s55, s55, 1024
  buffer_load_dwordx4 v1, s[8:11], s55 offen lds
  s_add_u32 m0, m0, 1056
  s_add_u32 s55, s55, 1024
  buffer_load_dwordx4 v1, s[8:11], s55 offen lds
  s_add_u32 m0, m0, 1056
  s_add_u32 s55, s55, 1024
  buffer_load_dwordx4 v1, s[8:11], s55 offen lds
  s_add_u32 s58, s54, 3
  s_and_b32 s58, s58, 3
  s_lshl_b32 s58, s58, 4
  s_add_u32 s58, s58, s57
  s_add_u32 s55, s50, s58
  s_lshl_b32 s55, s55, 10
  s_mul_i32 s56, s58, 1056
  s_add_u32 m0, s56, 29696
  s_nop 0
  buffer_load_dwordx4 v1, s[8:11], s55 offen lds
  s_add_u32 m0, m0, 1056
  s_add_u32 s55, s55, 1024
  buffer_load_dwordx4 v1, s[8:11], s55 offen lds
  s_add_u32 m0, m0, 1056
  s_add_u32 s55, s55, 1024
  buffer_load_dwordx4 v1, s[8:11], s55 offen lds
  s_add_u32 m0, m0, 1056
  s_add_u32 s55, s55, 1024
  buffer_load_dwordx4 v1, s[8:11], s55 offen lds
  s_waitcnt vmcnt(12)
  v_readfirstlane_b32 s49, v31
  s_nop 0
  s_mul_i32 s49, s49, 0x9E3779B1
  s_add_u32 s49, s49, 0x7F4A7C15
  s_lshl_b32 s55, s44, 14
  s_lshl_b32 s56, s48, 7
  s_add_u32 s55, s55, s56
  s_lshl_b32 s56, s44, 11
  s_add_u32 m0, s56, 97280
  s_nop 0
  buffer_load_dwordx4 v20, s[12:15], s55 offen lds
  s_add_u32 m0, m0, 1024
  s_add_u32 s55, s55, 8192
  buffer_load_dwordx4 v21, s[12:15], s55 offen lds
  s_add_u32 m0, m0, 7168
  s_add_u32 s55, s55, 57344
  buffer_load_dwordx4 v20, s[12:15], s55 offen lds
  s_add_u32 m0, m0, 1024
  s_add_u32 s55, s55, 8192
  buffer_load_dwordx4 v21, s[12:15], s55 offen lds
  s_add_u32 m0, m0, 7168
  s_add_u32 s55, s55, 57344
  buffer_load_dwordx4 v20, s[12:15], s55 offen lds
  s_add_u32 m0, m0, 1024
  s_add_u32 s55, s55, 8192
  buffer_load_dwordx4 v21, s[12:15], s55 offen lds
  s_add_u32 m0, m0, 7168
  s_add_u32 s55, s55, 57344
  buffer_load_dwordx4 v20, s[12:15], s55 offen lds
  s_add_u32 m0, m0, 1024
  s_add_u32 s55, s55, 8192
  buffer_load_dwordx4 v21, s[12:15], s55 offen lds
  s_add_u32 m0, m0, 7168
  s_add_u32 s55, s55, 57344
  buffer_load_dwordx4 v20, s[12:15], s55 offen lds
  s_add_u32 m0, m0, 1024
  s_add_u32 s55, s55, 8192
  buffer_load_dwordx4 v21, s[12:15], s55 offen lds
  s_add_u32 m0, m0, 7168
  s_add_u32 s55, s55, 57344
  buffer_load_dwordx4 v20, s[12:15], s55 offen lds
  s_add_u32 m0, m0, 1024
  s_add_u32 s55, s55, 8192
  buffer_load_dwordx4 v21, s[12:15], s55 offen lds
  s_add_u32 m0, m0, 7168
  s_add_u32 s55, s55, 57344
  buffer_load_dwordx4 v20, s[12:15], s55 offen lds
  s_add_u32 m0, m0, 1024
  s_add_u32 s55, s55, 8192
  buffer_load_dwordx4 v21, s[12:15], s55 offen lds
  s_add_u32 m0, m0, 7168
  s_add_u32 s55, s55, 57344
  buffer_load_dwordx4 v20, s[12:15], s55 offen lds
  s_add_u32 m0, m0, 1024
  s_add_u32 s55, s55, 8192
  buffer_load_dwordx4 v21, s[12:15], s55 offen lds
  s_waitcnt vmcnt(8)
L_p1j:
  s_barrier
  ds_read_b64_tr_b16 v[76:77], v28 offset:0
  ds_read_b64_tr_b16 v[78:79], v28 offset:512
  ds_read_b128 v[80:83], v19 offset:0
  ds_read_b128 v[84:87], v19 offset:16896
  ds_read_b64_tr_b16 v[88:89], v28 offset:4096
  ds_read_b64_tr_b16 v[90:91], v28 offset:4608
  ds_read_b128 v[92:95], v19 offset:64
  ds_read_b128 v[96:99], v19 offset:16960
  ds_read_b64_tr_b16 v[100:101], v28 offset:8192
  ds_read_b64_tr_b16 v[102:103], v28 offset:8704
  ds_read_b128 v[104:107], v19 offset:128
  ds_read_b128 v[108:111], v19 offset:17024
  s_mul_i32 s54, s44, 2064
  s_lshl_b32 s56, s79, 10
  s_add_u32 s56, s56, 1048576
  s_mov_b32 s58, 0x80000
  s_getreg_b32 s59, hwreg(HW_REG_XCC_ID)
  s_mov_b32 m0, s54
  s_mov_b32 s57, 4096
  s_cmp_eq_u32 s100, 0
  s_cbranch_scc1 L_ngf
  s_mov_b64 exec, 1
  s_waitcnt vmcnt(1)
  buffer_store_dwordx2 v[20:21], off, s[40:43], s101 sc1
  s_mov_b64 exec, -1
L_ngf:
  ds_read_b64_tr_b16 v[112:113], v28 offset:12288
  ds_read_b64_tr_b16 v[114:115], v28 offset:12800
  ds_read_b128 v[116:119], v19 offset:192
  ds_read_b128 v[120:123], v19 offset:17088
  s_waitcnt lgkmcnt(12)
  v_mfma_f32_16x16x32_bf16 v[32:35], v[76:79], v[80:83], 0
  v_mfma_f32_16x16x32_bf16 v[36:39], v[76:79], v[84:87], 0
  v_mfma_f32_16x16x32_bf16 v[40:43], v[76:79], v[8:11], 0
  ds_read_b64_tr_b16 v[76:77], v28 offset:16384
  ds_read_b64_tr_b16 v[78:79], v28 offset:16896
  ds_read_b128 v[80:83], v19 offset:256
  ds_read_b128 v[84:87], v19 offset:17152
  s_waitcnt lgkmcnt(12)
  v_mfma_f32_16x16x32_bf16 v[32:35], v[88:91], v[92:95], v[32:35]
  v_mfma_f32_16x16x32_bf16 v[36:39], v[88:91], v[96:99], v[36:39]
  v_mfma_f32_16x16x32_bf16 v[40:43], v[88:91], v[8:11], v[40:43]
  ds_read_b64_tr_b16 v[88:89], v28 offset:20480
  ds_read_b64_tr_b16 v[90:91], v28 offset:20992
  ds_read_b128 v[92:95], v19 offset:320
  ds_read_b128 v[96:99], v19 offset:17216
  s_waitcnt lgkmcnt(12)
  v_mfma_f32_16x16x32_bf16 v[32:35], v[100:103], v[104:107], v[32:35]
  v_mfma_f32_16x16x32_bf16 v[36:39], v[100:103], v[108:111], v[36:39]
  v_mfma_f32_16x16x32_bf16 v[40:43], v[100:103], v[8:11], v[40:43]
  ds_read_b64_tr_b16 v[100:101], v28 offset:24576
  ds_read_b64_tr_b16 v[102:103], v28 offset:25088
  ds_read_b128 v[104:107], v19 offset:384
  ds_read_b128 v[108:111], v19 offset:17280
  s_waitcnt lgkmcnt(12)
  v_mfma_f32_16x16x32_bf16 v[32:35], v[112:115], v[116:119], v[32:35]
  v_mfma_f32_16x16x32_bf16 v[36:39], v[112:115], v[120:123], v[36:39]
  v_mfma_f32_16x16x32_bf16 v[40:43], v[112:115], v[8:11], v[40:43]
  ds_read_b64_tr_b16 v[112:113], v28 offset:28672
  ds_read_b64_tr_b16 v[114:115], v28 offset:29184
  ds_read_b128 v[116:119], v19 offset:448
  ds_read_b128 v[120:123], v19 offset:17344
  s_waitcnt lgkmcnt(12)
  v_mfma_f32_16x16x32_bf16 v[32:35], v[76:79], v[80:83], v[32:35]
  v_mfma_f32_16x16x32_bf16 v[36:39], v[76:79], v[84:87], v[36:39]
  v_mfma_f32_16x16x32_bf16 v[40:43], v[76:79], v[8:11], v[40:43]
  s_cmp_lt_u32 s77, 4
  s_cbranch_scc1 L_nw2
  s_waitcnt vmcnt(0)
L_nw2:
  s_barrier
  v_not_b32 v22, s49
  s_mov_b64 exec, 0xff
  buffer_load_dwordx2 v[22:23], v15, s[40:43], s20 offen sc1
  s_mov_b64 exec, -1
  ds_read_b64_tr_b16 v[76:77], v28 offset:32768
  ds_read_b64_tr_b16 v[78:79], v28 offset:33280
  ds_read_b128 v[80:83], v19 offset:512
  ds_read_b128 v[84:87], v19 offset:17408
  s_waitcnt lgkmcnt(12)
  v_mfma_f32_16x16x32_bf16 v[32:35], v[88:91], v[92:95], v[32:35]
  v_mfma_f32_16x16x32_bf16 v[36:39], v[88:91], v[96:99], v[36:39]
  v_mfma_f32_16x16x32_bf16 v[40:43], v[88:91], v[8:11], v[40:43]
  ds_read_b64_tr_b16 v[88:89], v28 offset:36864
  ds_read_b64_tr_b16 v[90:91], v28 offset:37376
  ds_read_b128 v[92:95], v19 offset:576
  ds_read_b128 v[96:99], v19 offset:17472
  s_waitcnt lgkmcnt(12)
  v_mfma_f32_16x16x32_bf16 v[32:35], v[100:103], v[104:107], v[32:35]
  v_mfma_f32_16x16x32_bf16 v[36:39], v[100:103], v[108:111], v[36:39]
  v_mfma_f32_16x16x32_bf16 v[40:43], v[100:103], v[8:11], v[40:43]
  ds_read_b64_tr_b16 v[100:101], v28 offset:40960
  ds_read_b64_tr_b16 v[102:103], v28 offset:41472
  ds_read_b128 v[104:107], v19 offset:640
  ds_read_b128 v[108:111], v19 offset:17536
  s_waitcnt lgkmcnt(12)
  v_mfma_f32_16x16x32_bf16 v[32:35], v[112:115], v[116:119], v[32:35]
  v_mfma_f32_16x16x32_bf16 v[36:39], v[112:115], v[120:123], v[36:39]
  v_mfma_f32_16x16x32_bf16 v[40:43], v[112:115], v[8:11], v[40:43]
  ds_read_b64_tr_b16 v[112:113], v28 offset:45056
  ds_read_b64_tr_b16 v[114:115], v28 offset:45568
  ds_read_b128 v[116:119], v19 offset:704
  ds_read_b128 v[120:123], v19 offset:17600
  s_waitcnt lgkmcnt(12)
  v_mfma_f32_16x16x32_bf16 v[32:35], v[76:79], v[80:83], v[32:35]
  v_mfma_f32_16x16x32_bf16 v[36:39], v[76:79], v[84:87], v[36:39]
  v_mfma_f32_16x16x32_bf16 v[40:43], v[76:79], v[8:11], v[40:43]
  ds_read_b64_tr_b16 v[76:77], v28 offset:49152
  ds_read_b64_tr_b16 v[78:79], v28 offset:49664
  ds_read_b128 v[80:83], v19 offset:768
  ds_read_b128 v[84:87], v19 offset:17664
  s_waitcnt lgkmcnt(12)
  v_mfma_f32_16x16x32_bf16 v[32:35], v[88:91], v[92:95], v[32:35]
  v_mfma_f32_16x16x32_bf16 v[36:39], v[88:91], v[96:99], v[36:39]
  v_mfma_f32_16x16x32_bf16 v[40:43], v[88:91], v[8:11], v[40:43]
  ds_read_b64_tr_b16 v[88:89], v28 offset:53248
  ds_read_b64_tr_b16 v[90:91], v28 offset:53760
  ds_read_b128 v[92:95], v19 offset:832
  ds_read_b128 v[96:99], v19 offset:17728
  s_waitcnt lgkmcnt(12)
  v_mfma_f32_16x16x32_bf16 v[32:35], v[100:103], v[104:107], v[32:35]
  v_mfma_f32_16x16x32_bf16 v[36:39], v[100:103], v[108:111], v[36:39]
  v_mfma_f32_16x16x32_bf16 v[40:43], v[100:103], v[8:11], v[40:43]
  s_waitcnt vmcnt(0)
  v_cmp_ne_u32 vcc, s49, v22
  v_cmp_ne_u32 s[68:69], s59, v23
  s_nop 0
  s_or_b32 s97, vcc_lo, s68
  s_and_b32 s97, s97, 0xff
  s_cselect_b32 s96, 0, 524288
  s_cselect_b32 s98, 0xff00, 0
  s_and_b32 s97, s68, s98
  s_and_b32 s98, vcc_lo, s98
  s_cbranch_scc1 L_kv0_no
  s_add_u32 s55, s23, s96
  s_add_u32 s56, s56, s96
  buffer_load_dwordx2 v[24:25], v14, s[40:43], s55 offen offset:0 sc1
  buffer_load_dwordx2 v[26:27], v14, s[40:43], s55 offen offset:128 sc1
  buffer_load_dwordx4 v1, s[40:43], s56 offen sc1 lds
  s_add_u32 m0, s54, 1024
  s_add_u32 s56, s56, 65536
  buffer_load_dwordx4 v1, s[40:43], s56 offen sc1 lds
  s_mov_b32 s21, 1
L_kv0_no:
  ds_read_b64_tr_b16 v[100:101], v28 offset:57344
  ds_read_b64_tr_b16 v[102:103], v28 offset:57856
  ds_read_b128 v[104:107], v19 offset:896
  ds_read_b128 v[108:111], v19 offset:17792
  s_waitcnt lgkmcnt(12)
  v_mfma_f32_16x16x32_bf16 v[32:35], v[112:115], v[116:119], v[32:35]
  v_mfma_f32_16x16x32_bf16 v[36:39], v[112:115], v[120:123], v[36:39]
  v_mfma_f32_16x16x32_bf16 v[40:43], v[112:115], v[8:11], v[40:43]
  ds_read_b64_tr_b16 v[112:113], v28 offset:61440
  ds_read_b64_tr_b16 v[114:115], v28 offset:61952
  ds_read_b128 v[116:119], v19 offset:960
  ds_read_b128 v[120:123], v19 offset:17856
  s_waitcnt lgkmcnt(12)
  v_mfma_f32_16x16x32_bf16 v[32:35], v[76:79], v[80:83], v[32:35]
  v_mfma_f32_16x16x32_bf16 v[36:39], v[76:79], v[84:87], v[36:39]
  v_mfma_f32_16x16x32_bf16 v[40:43], v[76:79], v[8:11], v[40:43]
  s_waitcnt lgkmcnt(8)
  v_mfma_f32_16x16x32_bf16 v[32:35], v[88:91], v[92:95], v[32:35]
  v_mfma_f32_16x16x32_bf16 v[36:39], v[88:91], v[96:99], v[36:39]
  v_mfma_f32_16x16x32_bf16 v[40:43], v[88:91], v[8:11], v[40:43]
  s_waitcnt lgkmcnt(4)
  v_mfma_f32_16x16x32_bf16 v[32:35], v[100:103], v[104:107], v[32:35]
  v_mfma_f32_16x16x32_bf16 v[36:39], v[100:103], v[108:111], v[36:39]
  v_mfma_f32_16x16x32_bf16 v[40:43], v[100:103], v[8:11], v[40:43]
  s_waitcnt lgkmcnt(0)
  v_mfma_f32_16x16x32_bf16 v[32:35], v[112:115], v[116:119], v[32:35]
  v_mfma_f32_16x16x32_bf16 v[36:39], v[112:115], v[120:123], v[36:39]
  v_mfma_f32_16x16x32_bf16 v[40:43], v[112:115], v[8:11], v[40:43]
  s_cmp_lg_u32 s21, 0
  s_cbranch_scc1 L_kv0_done
L_kvpoll:
  buffer_load_dwordx2 v[22:23], v15, s[40:43], s20 offen sc1
  s_waitcnt vmcnt(0)
  s_sub_u32 s58, s58, 1
  s_cmp_eq_u32 s58, 0
  s_cbranch_scc1 L_kvpd
  v_cmp_ne_u32 vcc, s49, v22
  v_cmp_ne_u32 s[68:69], s59, v23
  s_nop 0
  s_or_b32 s97, vcc_lo, s68
  s_and_b32 s97, s97, 0xff
  s_cselect_b32 s96, 0, 524288
  s_cselect_b32 s98, 0xff00, 0
  s_and_b32 s97, s68, s98
  s_and_b32 s98, vcc_lo, s98
  s_cbranch_scc1 L_kvpoll
L_kvpd:
  s_add_u32 s55, s23, s96
  s_add_u32 s56, s56, s96
  buffer_load_dwordx2 v[24:25], v14, s[40:43], s55 offen offset:0 sc1
  buffer_load_dwordx2 v[26:27], v14, s[40:43], s55 offen offset:128 sc1
  buffer_load_dwordx4 v1, s[40:43], s56 offen sc1 lds
  s_add_u32 m0, s54, 1024
  s_add_u32 s56, s56, 65536
  buffer_load_dwordx4 v1, s[40:43], s56 offen sc1 lds
L_kv0_done:
  buffer_load_dword v20, v126, s[40:43], s57 offen sc1
  s_mov_b64 exec, 0xff
  ds_write_b128 v17, v[8:11]
  s_mov_b64 exec, -1
  v_mov_b32 v14, s97
  ds_write_b32 v16, v14
  s_waitcnt vmcnt(3)
  v_mul_f32 v25, 0x3eb8aa3b, v25
  v_mul_f32 v27, 0x3eb8aa3b, v27
  v_pk_fma_f32 v[32:33], v[24:25], v[40:41], v[32:33] op_sel_hi:[0,1,1] neg_lo:[1,0,0] neg_hi:[1,0,0]
  v_pk_fma_f32 v[36:37], v[26:27], v[40:41], v[36:37] op_sel_hi:[0,1,1] neg_lo:[1,0,0] neg_hi:[1,0,0]
  v_pk_fma_f32 v[34:35], v[24:25], v[42:43], v[34:35] op_sel_hi:[0,1,1] neg_lo:[1,0,0] neg_hi:[1,0,0]
  v_pk_fma_f32 v[38:39], v[26:27], v[42:43], v[38:39] op_sel_hi:[0,1,1] neg_lo:[1,0,0] neg_hi:[1,0,0]
  v_pk_mul_f32 v[32:33], v[32:33], v[24:25] op_sel:[0,1] op_sel_hi:[1,1]
  v_pk_mul_f32 v[36:37], v[36:37], v[26:27] op_sel:[0,1] op_sel_hi:[1,1]
  v_pk_mul_f32 v[34:35], v[34:35], v[24:25] op_sel:[0,1] op_sel_hi:[1,1]
  v_pk_mul_f32 v[38:39], v[38:39], v[26:27] op_sel:[0,1] op_sel_hi:[1,1]
  v_cvt_pk_bf16_f32 v112, v32, v33
  v_cvt_pk_bf16_f32 v113, v34, v35
  v_cvt_pk_bf16_f32 v114, v36, v37
  v_cvt_pk_bf16_f32 v115, v38, v39
  s_nop 0
  v_permlane16_swap_b32 v112, v114
  v_permlane16_swap_b32 v113, v115
  s_waitcnt vmcnt(1) lgkmcnt(0)
  s_barrier
  ds_read_b32 v24, v18
  ds_write_b128 v17, v[8:11]
  ds_read_b128 v[88:91], v125 offset:0
  ds_read_b128 v[92:95], v125 offset:2064
  ds_read_b128 v[96:99], v3 offset:0
  ds_read_b128 v[100:103], v4 offset:0
  s_waitcnt lgkmcnt(3)
  v_mfma_f32_32x32x16_bf16 v[32:47], v[88:91], v[112:115], 0
  v_mov_b32 v72, 0
  v_mov_b32 v73, 0
  v_mov_b32 v74, 0
  v_mov_b32 v75, 0
  v_mov_b32 v76, 0
  v_mov_b32 v77, 0
  v_mov_b32 v78, 0
  v_mov_b32 v79, 0
  v_mov_b32 v80, 0
  v_mov_b32 v81, 0
  v_mov_b32 v82, 0
  v_mov_b32 v83, 0
  v_mov_b32 v84, 0
  v_mov_b32 v85, 0
  v_mov_b32 v86, 0
  v_mov_b32 v87, 0
  v_mov_b32 v64, 0xdddd
  v_exp_f32 v32, v32
  v_exp_f32 v33, v33
  ds_read_b128 v[104:107], v3 offset:2064
  ds_read_b128 v[108:111], v4 offset:2064
  v_exp_f32 v34, v34
  v_exp_f32 v35, v35
  v_exp_f32 v36, v36
  v_exp_f32 v37, v37
  s_waitcnt lgkmcnt(4)
  v_mfma_f32_32x32x16_bf16 v[48:63], v[92:95], v[112:115], 0
  ds_read_b128 v[88:91], v125 offset:4128
  v_cmp_ne_u32 vcc, 0, v24
  s_nop 0
  s_cmp_eq_u64 vcc, 0
  s_cselect_b32 s64, 1, 0
  s_setprio 2
  v_exp_f32 v38, v38
  v_exp_f32 v39, v39
  v_exp_f32 v40, v40
  v_exp_f32 v41, v41
  v_exp_f32 v42, v42
  s_waitcnt lgkmcnt(3)
  v_smfmac_f32_32x32x32_bf16 v[72:87], v[96:99], v[32:39], v64
  s_waitcnt vmcnt(0)
  v_cmp_ne_u32 vcc, s49, v20
  s_cbranch_vccnz L_pr_1
L_pj_2:
  s_add_u32 m0, s54, 16512
  s_add_u32 s56, s79, 8
  s_and_b32 s56, s56, 63
  s_lshl_b32 s56, s56, 10
  s_add_u32 s56, s56, 1048576
  buffer_load_dwordx4 v1, s[40:43], s56 offen sc1 lds
  v_exp_f32 v43, v43
  v_exp_f32 v44, v44
  v_exp_f32 v45, v45
  v_exp_f32 v46, v46
  v_exp_f32 v47, v47
  v_exp_f32 v48, v48
  v_exp_f32 v49, v49
  v_smfmac_f32_32x32x32_bf16 v[72:87], v[100:103], v[40:47], v64
  ds_read_b128 v[96:99], v3 offset:4128
  ds_read_b128 v[100:103], v4 offset:4128
  v_exp_f32 v50, v50
  v_exp_f32 v51, v51
  v_exp_f32 v52, v52
  v_exp_f32 v53, v53
  s_waitcnt lgkmcnt(2)
  v_mfma_f32_32x32x16_bf16 v[32:47], v[88:91], v[112:115], 0
  ds_read_b128 v[92:95], v125 offset:6192
  s_add_u32 m0, s54, 17536
  s_add_u32 s56, s79, 8
  s_and_b32 s56, s56, 63
  s_lshl_b32 s56, s56, 10
  s_add_u32 s56, s56, 1114112
  buffer_load_dwordx4 v1, s[40:43], s56 offen sc1 lds
  v_exp_f32 v54, v54
  v_exp_f32 v55, v55
  v_exp_f32 v56, v56
  v_exp_f32 v57, v57
  v_exp_f32 v58, v58
  v_smfmac_f32_32x32x32_bf16 v[72:87], v[104:107], v[48:55], v64
  s_add_u32 m0, s54, 33024
  s_add_u32 s56, s79, 16
  s_and_b32 s56, s56, 63
  s_lshl_b32 s56, s56, 10
  s_add_u32 s56, s56, 1048576
  buffer_load_dwordx4 v1, s[40:43], s56 offen sc1 lds
  v_exp_f32 v59, v59
  v_exp_f32 v60, v60
  v_exp_f32 v61, v61
  v_exp_f32 v62, v62
  v_exp_f32 v63, v63
  v_exp_f32 v32, v32
  v_exp_f32 v33, v33
  v_smfmac_f32_32x32x32_bf16 v[72:87], v[108:111], v[56:63], v64
  ds_read_b128 v[104:107], v3 offset:6192
  ds_read_b128 v[108:111], v4 offset:6192
  v_exp_f32 v34, v34
  v_exp_f32 v35, v35
  v_exp_f32 v36, v36
  v_exp_f32 v37, v37
  s_waitcnt lgkmcnt(2)
  v_mfma_f32_32x32x16_bf16 v[48:63], v[92:95], v[112:115], 0
  ds_read_b128 v[88:91], v125 offset:8256
  s_add_u32 m0, s54, 34048
  s_add_u32 s56, s79, 16
  s_and_b32 s56, s56, 63
  s_lshl_b32 s56, s56, 10
  s_add_u32 s56, s56, 1114112
  buffer_load_dwordx4 v1, s[40:43], s56 offen sc1 lds
  v_exp_f32 v38, v38
  v_exp_f32 v39, v39
  v_exp_f32 v40, v40
  v_exp_f32 v41, v41
  v_exp_f32 v42, v42
  v_smfmac_f32_32x32x32_bf16 v[72:87], v[96:99], v[32:39], v64
  v_exp_f32 v43, v43
  v_exp_f32 v44, v44
  v_exp_f32 v45, v45
  v_exp_f32 v46, v46
  v_exp_f32 v47, v47
  v_exp_f32 v48, v48
  v_exp_f32 v49, v49
  v_smfmac_f32_32x32x32_bf16 v[72:87], v[100:103], v[40:47], v64
  ds_read_b128 v[96:99], v3 offset:8256
  ds_read_b128 v[100:103], v4 offset:8256
  v_exp_f32 v50, v50
  v_exp_f32 v51, v51
  v_exp_f32 v52, v52
  v_exp_f32 v53, v53
  s_waitcnt lgkmcnt(2)
  v_mfma_f32_32x32x16_bf16 v[32:47], v[88:91], v[112:115], 0
  ds_read_b128 v[92:95], v125 offset:10320
  s_add_u32 m0, s54, 49536
  s_add_u32 s56, s79, 24
  s_and_b32 s56, s56, 63
  s_lshl_b32 s56, s56, 10
  s_add_u32 s56, s56, 1048576
  buffer_load_dwordx4 v1, s[40:43], s56 offen sc1 lds
  s_setprio 1
  v_exp_f32 v54, v54
  v_exp_f32 v55, v55
  v_exp_f32 v56, v56
  v_exp_f32 v57, v57
  v_exp_f32 v58, v58
  v_smfmac_f32_32x32x32_bf16 v[72:87], v[104:107], v[48:55], v64
  s_add_u32 m0, s54, 50560
  s_add_u32 s56, s79, 24
  s_and_b32 s56, s56, 63
  s_lshl_b32 s56, s56, 10
  s_add_u32 s56, s56, 1114112
  buffer_load_dwordx4 v1, s[40:43], s56 offen sc1 lds
  v_exp_f32 v59, v59
  v_exp_f32 v60, v60
  v_exp_f32 v61, v61
  v_exp_f32 v62, v62
  v_exp_f32 v63, v63
  v_exp_f32 v32, v32
  v_exp_f32 v33, v33
  v_smfmac_f32_32x32x32_bf16 v[72:87], v[108:111], v[56:63], v64
  ds_read_b128 v[104:107], v3 offset:10320
  ds_read_b128 v[108:111], v4 offset:10320
  v_exp_f32 v34, v34
  v_exp_f32 v35, v35
  v_exp_f32 v36, v36
  v_exp_f32 v37, v37
  s_waitcnt lgkmcnt(2)
  v_mfma_f32_32x32x16_bf16 v[48:63], v[92:95], v[112:115], 0
  ds_read_b128 v[88:91], v125 offset:12384
  s_add_u32 m0, s54, 66048
  s_add_u32 s56, s79, 32
  s_and_b32 s56, s56, 63
  s_lshl_b32 s56, s56, 10
  s_add_u32 s56, s56, 1048576
  buffer_load_dwordx4 v1, s[40:43], s56 offen sc1 lds
  v_exp_f32 v38, v38
  v_exp_f32 v39, v39
  v_exp_f32 v40, v40
  v_exp_f32 v41, v41
  v_exp_f32 v42, v42
  v_smfmac_f32_32x32x32_bf16 v[72:87], v[96:99], v[32:39], v64
  s_add_u32 m0, s54, 67072
  s_add_u32 s56, s79, 32
  s_and_b32 s56, s56, 63
  s_lshl_b32 s56, s56, 10
  s_add_u32 s56, s56, 1114112
  buffer_load_dwordx4 v1, s[40:43], s56 offen sc1 lds
  s_setprio 0
  v_exp_f32 v43, v43
  v_exp_f32 v44, v44
  v_exp_f32 v45, v45
  v_exp_f32 v46, v46
  v_exp_f32 v47, v47
  v_exp_f32 v48, v48
  v_exp_f32 v49, v49
  v_smfmac_f32_32x32x32_bf16 v[72:87], v[100:103], v[40:47], v64
  ds_read_b128 v[96:99], v3 offset:12384
  ds_read_b128 v[100:103], v4 offset:12384
  v_exp_f32 v50, v50
  v_exp_f32 v51, v51
  v_exp_f32 v52, v52
  v_exp_f32 v53, v53
  s_waitcnt lgkmcnt(2)
  v_mfma_f32_32x32x16_bf16 v[32:47], v[88:91], v[112:115], 0
  ds_read_b128 v[92:95], v125 offset:14448
  v_exp_f32 v54, v54
  v_exp_f32 v55, v55
  v_exp_f32 v56, v56
  v_exp_f32 v57, v57
  v_exp_f32 v58, v58
  v_smfmac_f32_32x32x32_bf16 v[72:87], v[104:107], v[48:55], v64
  s_waitcnt vmcnt(4)
  s_barrier
  s_mov_b32 exec_lo, 0x7f
  s_mov_b32 exec_hi, 0x0
  global_load_dword v126, v7, s[84:85]
  global_load_dword v126, v7, s[86:87]
  global_load_dword v126, v7, s[88:89]
  s_mov_b32 exec_lo, 3
  global_load_dword v126, v7, s[80:81]
  s_mov_b64 exec, -1
  s_setprio 3
  v_exp_f32 v59, v59
  v_exp_f32 v60, v60
  v_exp_f32 v61, v61
  v_exp_f32 v62, v62
  v_exp_f32 v63, v63
  v_exp_f32 v32, v32
  v_exp_f32 v33, v33
  v_smfmac_f32_32x32x32_bf16 v[72:87], v[108:111], v[56:63], v64
  ds_read_b128 v[104:107], v3 offset:14448
  ds_read_b128 v[108:111], v4 offset:14448
  v_exp_f32 v34, v34
  v_exp_f32 v35, v35
  v_exp_f32 v36, v36
  v_exp_f32 v37, v37
  s_waitcnt lgkmcnt(2)
  v_mfma_f32_32x32x16_bf16 v[48:63], v[92:95], v[112:115], 0
  ds_read_b128 v[88:91], v125 offset:16512
  s_mov_b32 exec_lo, 0x7f0000
  s_mov_b32 exec_hi, 0x0
  buffer_load_dword v126, v5, s[40:43], 0 offen
  s_mov_b64 exec, -1
  v_exp_f32 v38, v38
  v_exp_f32 v39, v39
  v_exp_f32 v40, v40
  v_exp_f32 v41, v41
  v_exp_f32 v42, v42
  v_smfmac_f32_32x32x32_bf16 v[72:87], v[96:99], v[32:39], v64
  v_exp_f32 v43, v43
  v_exp_f32 v44, v44
  v_exp_f32 v45, v45
  v_exp_f32 v46, v46
  v_exp_f32 v47, v47
  v_exp_f32 v48, v48
  v_exp_f32 v49, v49
  v_smfmac_f32_32x32x32_bf16 v[72:87], v[100:103], v[40:47], v64
  ds_read_b128 v[96:99], v3 offset:16512
  ds_read_b128 v[100:103], v4 offset:16512
  v_exp_f32 v50, v50
  v_exp_f32 v51, v51
  v_exp_f32 v52, v52
  v_exp_f32 v53, v53
  s_waitcnt lgkmcnt(2)
  v_mfma_f32_32x32x16_bf16 v[32:47], v[88:91], v[112:115], 0
  ds_read_b128 v[92:95], v125 offset:18576
  v_exp_f32 v54, v54
  v_exp_f32 v55, v55
  v_exp_f32 v56, v56
  v_exp_f32 v57, v57
  v_exp_f32 v58, v58
  v_smfmac_f32_32x32x32_bf16 v[72:87], v[104:107], v[48:55], v64
  v_exp_f32 v59, v59
  v_exp_f32 v60, v60
  v_exp_f32 v61, v61
  v_exp_f32 v62, v62
  v_exp_f32 v63, v63
  v_exp_f32 v32, v32
  v_exp_f32 v33, v33
  v_smfmac_f32_32x32x32_bf16 v[72:87], v[108:111], v[56:63], v64
  ds_read_b128 v[104:107], v3 offset:18576
  ds_read_b128 v[108:111], v4 offset:18576
  v_exp_f32 v34, v34
  v_exp_f32 v35, v35
  v_exp_f32 v36, v36
  v_exp_f32 v37, v37
  s_waitcnt lgkmcnt(2)
  v_mfma_f32_32x32x16_bf16 v[48:63], v[92:95], v[112:115], 0
  ds_read_b128 v[88:91], v125 offset:20640
  v_exp_f32 v38, v38
  v_exp_f32 v39, v39
  v_exp_f32 v40, v40
  v_exp_f32 v41, v41
  v_exp_f32 v42, v42
  v_smfmac_f32_32x32x32_bf16 v[72:87], v[96:99], v[32:39], v64
  v_exp_f32 v43, v43
  v_exp_f32 v44, v44
  v_exp_f32 v45, v45
  v_exp_f32 v46, v46
  v_exp_f32 v47, v47
  v_exp_f32 v48, v48
  v_exp_f32 v49, v49
  v_smfmac_f32_32x32x32_bf16 v[72:87], v[100:103], v[40:47], v64
  ds_read_b128 v[96:99], v3 offset:20640
  ds_read_b128 v[100:103], v4 offset:20640
  v_exp_f32 v50, v50
  v_exp_f32 v51, v51
  v_exp_f32 v52, v52
  v_exp_f32 v53, v53
  s_waitcnt lgkmcnt(2)
  v_mfma_f32_32x32x16_bf16 v[32:47], v[88:91], v[112:115], 0
  ds_read_b128 v[92:95], v125 offset:22704
  v_exp_f32 v54, v54
  v_exp_f32 v55, v55
  v_exp_f32 v56, v56
  v_exp_f32 v57, v57
  v_exp_f32 v58, v58
  v_smfmac_f32_32x32x32_bf16 v[72:87], v[104:107], v[48:55], v64
  v_exp_f32 v59, v59
  v_exp_f32 v60, v60
  v_exp_f32 v61, v61
  v_exp_f32 v62, v62
  v_exp_f32 v63, v63
  v_exp_f32 v32, v32
  v_exp_f32 v33, v33
  v_smfmac_f32_32x32x32_bf16 v[72:87], v[108:111], v[56:63], v64
  ds_read_b128 v[104:107], v3 offset:22704
  ds_read_b128 v[108:111], v4 offset:22704
  v_exp_f32 v34, v34
  v_exp_f32 v35, v35
  v_exp_f32 v36, v36
  v_exp_f32 v37, v37
  s_waitcnt lgkmcnt(2)
  v_mfma_f32_32x32x16_bf16 v[48:63], v[92:95], v[112:115], 0
  ds_read_b128 v[88:91], v125 offset:24768
  v_exp_f32 v38, v38
  v_exp_f32 v39, v39
  v_exp_f32 v40, v40
  v_exp_f32 v41, v41
  v_exp_f32 v42, v42
  v_smfmac_f32_32x32x32_bf16 v[72:87], v[96:99], v[32:39], v64
  v_exp_f32 v43, v43
  v_exp_f32 v44, v44
  v_exp_f32 v45, v45
  v_exp_f32 v46, v46
  v_exp_f32 v47, v47
  v_exp_f32 v48, v48
  v_exp_f32 v49, v49
  v_smfmac_f32_32x32x32_bf16 v[72:87], v[100:103], v[40:47], v64
  ds_read_b128 v[96:99], v3 offset:24768
  ds_read_b128 v[100:103], v4 offset:24768
  v_exp_f32 v50, v50
  v_exp_f32 v51, v51
  v_exp_f32 v52, v52
  v_exp_f32 v53, v53
  s_waitcnt lgkmcnt(2)
  v_mfma_f32_32x32x16_bf16 v[32:47], v[88:91], v[112:115], 0
  ds_read_b128 v[92:95], v125 offset:26832
  s_cmp_ge_u32 s44, 4
  s_cbranch_scc1 L_pa_4
  s_add_u32 m0, s74, 0
  s_nop 0
  buffer_load_dwordx4 v12, s[24:27], s72 offen offset:0 lds
  s_branch L_pb_5
L_pa_4:
  s_add_u32 m0, s78, 0
  s_nop 0
  buffer_load_dwordx4 v124, s[32:35], s75 offen offset:0 lds
L_pb_5:
  v_exp_f32 v54, v54
  v_exp_f32 v55, v55
  v_exp_f32 v56, v56
  v_exp_f32 v57, v57
  v_exp_f32 v58, v58
  v_smfmac_f32_32x32x32_bf16 v[72:87], v[104:107], v[48:55], v64
  s_cmp_ge_u32 s44, 4
  s_cbranch_scc1 L_pa_6
  s_add_u32 m0, s74, 960
  s_nop 0
  buffer_load_dwordx4 v12, s[24:27], s72 offen offset:64 lds
  s_branch L_pb_7
L_pa_6:
  s_add_u32 m0, s78, 896
  s_nop 0
  buffer_load_dwordx4 v124, s[32:35], s75 offen offset:128 lds
L_pb_7:
  v_exp_f32 v59, v59
  v_exp_f32 v60, v60
  v_exp_f32 v61, v61
  v_exp_f32 v62, v62
  v_exp_f32 v63, v63
  v_exp_f32 v32, v32
  v_exp_f32 v33, v33
  v_smfmac_f32_32x32x32_bf16 v[72:87], v[108:111], v[56:63], v64
  ds_read_b128 v[104:107], v3 offset:26832
  ds_read_b128 v[108:111], v4 offset:26832
  v_exp_f32 v34, v34
  v_exp_f32 v35, v35
  v_exp_f32 v36, v36
  v_exp_f32 v37, v37
  s_waitcnt lgkmcnt(2)
  v_mfma_f32_32x32x16_bf16 v[48:63], v[92:95], v[112:115], 0
  ds_read_b128 v[88:91], v125 offset:28896
  s_cmp_ge_u32 s44, 4
  s_cbranch_scc1 L_pa_8
  s_add_u32 m0, s74, 2048
  s_nop 0
  buffer_load_dwordx4 v12, s[28:31], s72 offen offset:0 lds
  s_branch L_pb_9
L_pa_8:
  s_add_u32 m0, s78, 2016
  s_nop 0
  buffer_load_dwordx4 v124, s[32:35], s75 offen offset:32 lds
L_pb_9:
  v_exp_f32 v38, v38
  v_exp_f32 v39, v39
  v_exp_f32 v40, v40
  v_exp_f32 v41, v41
  v_exp_f32 v42, v42
  v_smfmac_f32_32x32x32_bf16 v[72:87], v[96:99], v[32:39], v64
  s_cmp_ge_u32 s44, 4
  s_cbranch_scc1 L_pa_10
  s_add_u32 m0, s74, 3008
  s_nop 0
  buffer_load_dwordx4 v12, s[28:31], s72 offen offset:64 lds
  s_branch L_pb_11
L_pa_10:
  s_add_u32 m0, s78, 2912
  s_nop 0
  buffer_load_dwordx4 v124, s[32:35], s75 offen offset:160 lds
L_pb_11:
  v_exp_f32 v43, v43
  v_exp_f32 v44, v44
  v_exp_f32 v45, v45
  v_exp_f32 v46, v46
  v_exp_f32 v47, v47
  v_exp_f32 v48, v48
  v_exp_f32 v49, v49
  v_smfmac_f32_32x32x32_bf16 v[72:87], v[100:103], v[40:47], v64
  ds_read_b128 v[96:99], v3 offset:28896
  ds_read_b128 v[100:103], v4 offset:28896
  v_exp_f32 v50, v50
  v_exp_f32 v51, v51
  v_exp_f32 v52, v52
  v_exp_f32 v53, v53
  s_waitcnt lgkmcnt(2)
  v_mfma_f32_32x32x16_bf16 v[32:47], v[88:91], v[112:115], 0
  ds_read_b128 v[92:95], v125 offset:30960
  s_setprio 2
  v_exp_f32 v54, v54
  v_exp_f32 v55, v55
  v_exp_f32 v56, v56
  v_exp_f32 v57, v57
  v_exp_f32 v58, v58
  v_smfmac_f32_32x32x32_bf16 v[72:87], v[104:107], v[48:55], v64
  v_exp_f32 v59, v59
  v_exp_f32 v60, v60
  v_exp_f32 v61, v61
  v_exp_f32 v62, v62
  v_exp_f32 v63, v63
  v_exp_f32 v32, v32
  v_exp_f32 v33, v33
  v_smfmac_f32_32x32x32_bf16 v[72:87], v[108:111], v[56:63], v64
  ds_read_b128 v[104:107], v3 offset:30960
  ds_read_b128 v[108:111], v4 offset:30960
  v_exp_f32 v34, v34
  v_exp_f32 v35, v35
  v_exp_f32 v36, v36
  v_exp_f32 v37, v37
  s_waitcnt lgkmcnt(2)
  v_mfma_f32_32x32x16_bf16 v[48:63], v[92:95], v[112:115], 0
  ds_read_b128 v[88:91], v125 offset:33024
  v_exp_f32 v38, v38
  v_exp_f32 v39, v39
  v_exp_f32 v40, v40
  v_exp_f32 v41, v41
  v_exp_f32 v42, v42
  v_smfmac_f32_32x32x32_bf16 v[72:87], v[96:99], v[32:39], v64
  s_waitcnt vmcnt(0)
  ds_read_b64_tr_b16 v[8:9], v6 offset:0
  ds_read_b64_tr_b16 v[10:11], v6 offset:512
  ds_read_b64_tr_b16 v[12:13], v6 offset:32
  ds_read_b64_tr_b16 v[14:15], v6 offset:544
  ds_read_b64_tr_b16 v[16:17], v6 offset:1024
  ds_read_b64_tr_b16 v[18:19], v6 offset:1536
  ds_read_b64_tr_b16 v[20:21], v6 offset:1056
  ds_read_b64_tr_b16 v[22:23], v6 offset:1568
  v_exp_f32 v43, v43
  v_exp_f32 v44, v44
  v_exp_f32 v45, v45
  v_exp_f32 v46, v46
  v_exp_f32 v47, v47
  v_exp_f32 v48, v48
  v_exp_f32 v49, v49
  v_smfmac_f32_32x32x32_bf16 v[72:87], v[100:103], v[40:47], v64
  ds_read_b128 v[96:99], v3 offset:33024
  ds_read_b128 v[100:103], v4 offset:33024
  v_exp_f32 v50, v50
  v_exp_f32 v51, v51
  v_exp_f32 v52, v52
  v_exp_f32 v53, v53
  s_waitcnt lgkmcnt(10)
  v_mfma_f32_32x32x16_bf16 v[32:47], v[88:91], v[112:115], 0
  ds_read_b128 v[92:95], v125 offset:35088
  s_mov_b32 s59, s76
  s_waitcnt lgkmcnt(9)
  buffer_store_dwordx4 v[8:11], v1, s[40:43], s59 offen sc1
  v_exp_f32 v54, v54
  v_exp_f32 v55, v55
  v_exp_f32 v56, v56
  v_exp_f32 v57, v57
  v_exp_f32 v58, v58
  v_smfmac_f32_32x32x32_bf16 v[72:87], v[104:107], v[48:55], v64
  s_add_u32 s59, s76, s73
  s_waitcnt lgkmcnt(7)
  buffer_store_dwordx4 v[12:15], v1, s[40:43], s59 offen sc1
  v_exp_f32 v59, v59
  v_exp_f32 v60, v60
  v_exp_f32 v61, v61
  v_exp_f32 v62, v62
  v_exp_f32 v63, v63
  v_exp_f32 v32, v32
  v_exp_f32 v33, v33
  v_smfmac_f32_32x32x32_bf16 v[72:87], v[108:111], v[56:63], v64
  ds_read_b128 v[104:107], v3 offset:35088
  ds_read_b128 v[108:111], v4 offset:35088
  v_exp_f32 v34, v34
  v_exp_f32 v35, v35
  v_exp_f32 v36, v36
  v_exp_f32 v37, v37
  s_waitcnt lgkmcnt(2)
  v_mfma_f32_32x32x16_bf16 v[48:63], v[92:95], v[112:115], 0
  ds_read_b128 v[88:91], v125 offset:37152
  s_add_u32 s59, s76, s82
  buffer_store_dwordx4 v[16:19], v1, s[40:43], s59 offen sc1
  v_exp_f32 v38, v38
  v_exp_f32 v39, v39
  v_exp_f32 v40, v40
  v_exp_f32 v41, v41
  v_exp_f32 v42, v42
  v_smfmac_f32_32x32x32_bf16 v[72:87], v[96:99], v[32:39], v64
  s_add_u32 s59, s59, s73
  buffer_store_dwordx4 v[20:23], v1, s[40:43], s59 offen sc1
  v_exp_f32 v43, v43
  v_exp_f32 v44, v44
  v_exp_f32 v45, v45
  v_exp_f32 v46, v46
  v_exp_f32 v47, v47
  v_exp_f32 v48, v48
  v_exp_f32 v49, v49
  v_smfmac_f32_32x32x32_bf16 v[72:87], v[100:103], v[40:47], v64
  ds_read_b128 v[96:99], v3 offset:37152
  ds_read_b128 v[100:103], v4 offset:37152
  v_exp_f32 v50, v50
  v_exp_f32 v51, v51
  v_exp_f32 v52, v52
  v_exp_f32 v53, v53
  s_waitcnt lgkmcnt(2)
  v_mfma_f32_32x32x16_bf16 v[32:47], v[88:91], v[112:115], 0
  ds_read_b128 v[92:95], v125 offset:39216
  v_exp_f32 v54, v54
  v_exp_f32 v55, v55
  v_exp_f32 v56, v56
  v_exp_f32 v57, v57
  v_exp_f32 v58, v58
  v_smfmac_f32_32x32x32_bf16 v[72:87], v[104:107], v[48:55], v64
  s_mov_b32 exec_lo, 0xffff
  s_mov_b32 exec_hi, 0x0
  buffer_load_dword v126, v5, s[40:43], 0 offen
  s_mov_b64 exec, -1
  v_exp_f32 v59, v59
  v_exp_f32 v60, v60
  v_exp_f32 v61, v61
  v_exp_f32 v62, v62
  v_exp_f32 v63, v63
  v_exp_f32 v32, v32
  v_exp_f32 v33, v33
  v_smfmac_f32_32x32x32_bf16 v[72:87], v[108:111], v[56:63], v64
  ds_read_b128 v[104:107], v3 offset:39216
  ds_read_b128 v[108:111], v4 offset:39216
  v_exp_f32 v34, v34
  v_exp_f32 v35, v35
  v_exp_f32 v36, v36
  v_exp_f32 v37, v37
  s_waitcnt lgkmcnt(2)
  v_mfma_f32_32x32x16_bf16 v[48:63], v[92:95], v[112:115], 0
  ds_read_b128 v[88:91], v125 offset:41280
  v_exp_f32 v38, v38
  v_exp_f32 v39, v39
  v_exp_f32 v40, v40
  v_exp_f32 v41, v41
  v_exp_f32 v42, v42
  v_smfmac_f32_32x32x32_bf16 v[72:87], v[96:99], v[32:39], v64
  s_setprio 1
  v_exp_f32 v43, v43
  v_exp_f32 v44, v44
  v_exp_f32 v45, v45
  v_exp_f32 v46, v46
  v_exp_f32 v47, v47
  v_exp_f32 v48, v48
  v_exp_f32 v49, v49
  v_smfmac_f32_32x32x32_bf16 v[72:87], v[100:103], v[40:47], v64
  ds_read_b128 v[96:99], v3 offset:41280
  ds_read_b128 v[100:103], v4 offset:41280
  v_exp_f32 v50, v50
  v_exp_f32 v51, v51
  v_exp_f32 v52, v52
  v_exp_f32 v53, v53
  s_waitcnt lgkmcnt(2)
  v_mfma_f32_32x32x16_bf16 v[32:47], v[88:91], v[112:115], 0
  ds_read_b128 v[92:95], v125 offset:43344
  v_exp_f32 v54, v54
  v_exp_f32 v55, v55
  v_exp_f32 v56, v56
  v_exp_f32 v57, v57
  v_exp_f32 v58, v58
  v_smfmac_f32_32x32x32_bf16 v[72:87], v[104:107], v[48:55], v64
  v_exp_f32 v59, v59
  v_exp_f32 v60, v60
  v_exp_f32 v61, v61
  v_exp_f32 v62, v62
  v_exp_f32 v63, v63
  v_exp_f32 v32, v32
  v_exp_f32 v33, v33
  v_smfmac_f32_32x32x32_bf16 v[72:87], v[108:111], v[56:63], v64
  ds_read_b128 v[104:107], v3 offset:43344
  ds_read_b128 v[108:111], v4 offset:43344
  v_exp_f32 v34, v34
  v_exp_f32 v35, v35
  v_exp_f32 v36, v36
  v_exp_f32 v37, v37
  s_waitcnt lgkmcnt(2)
  v_mfma_f32_32x32x16_bf16 v[48:63], v[92:95], v[112:115], 0
  ds_read_b128 v[88:91], v125 offset:45408
  v_exp_f32 v38, v38
  v_exp_f32 v39, v39
  v_exp_f32 v40, v40
  v_exp_f32 v41, v41
  v_exp_f32 v42, v42
  v_smfmac_f32_32x32x32_bf16 v[72:87], v[96:99], v[32:39], v64
  s_setprio 0
  v_exp_f32 v43, v43
  v_exp_f32 v44, v44
  v_exp_f32 v45, v45
  v_exp_f32 v46, v46
  v_exp_f32 v47, v47
  v_exp_f32 v48, v48
  v_exp_f32 v49, v49
  v_smfmac_f32_32x32x32_bf16 v[72:87], v[100:103], v[40:47], v64
  ds_read_b128 v[96:99], v3 offset:45408
  ds_read_b128 v[100:103], v4 offset:45408
  v_exp_f32 v50, v50
  v_exp_f32 v51, v51
  v_exp_f32 v52, v52
  v_exp_f32 v53, v53
  s_waitcnt lgkmcnt(2)
  v_mfma_f32_32x32x16_bf16 v[32:47], v[88:91], v[112:115], 0
  ds_read_b128 v[92:95], v125 offset:47472
  v_exp_f32 v54, v54
  v_exp_f32 v55, v55
  v_exp_f32 v56, v56
  v_exp_f32 v57, v57
  v_exp_f32 v58, v58
  v_smfmac_f32_32x32x32_bf16 v[72:87], v[104:107], v[48:55], v64
  s_waitcnt vmcnt(1)
  s_barrier
  s_cmp_lg_u32 s44, 7
  s_cbranch_scc1 L_tf1_skip
  s_lshr_b32 s56, s53, 2
  s_lshl_b32 s56, s56, 7
  s_and_b32 s57, s53, 3
  s_lshl_b32 s57, s57, 2
  s_add_u32 s56, s56, s57
  s_add_u32 s56, s56, 12288
  v_mov_b32 v26, s49
  s_mov_b64 exec, 1
  buffer_store_dword v26, off, s[40:43], s56 sc1
  s_cmp_lg_u32 s2, 0
  s_cbranch_scc1 L_ep_skip
  buffer_store_dword v26, off, s[40:43], 0 sc1
L_ep_skip:
  s_mov_b64 exec, -1
L_tf1_skip:
  s_setprio 3
  v_exp_f32 v59, v59
  v_exp_f32 v60, v60
  v_exp_f32 v61, v61
  v_exp_f32 v62, v62
  v_exp_f32 v63, v63
  v_exp_f32 v32, v32
  v_exp_f32 v33, v33
  v_smfmac_f32_32x32x32_bf16 v[72:87], v[108:111], v[56:63], v64
  ds_read_b128 v[104:107], v3 offset:47472
  ds_read_b128 v[108:111], v4 offset:47472
  v_exp_f32 v34, v34
  v_exp_f32 v35, v35
  v_exp_f32 v36, v36
  v_exp_f32 v37, v37
  s_waitcnt lgkmcnt(2)
  v_mfma_f32_32x32x16_bf16 v[48:63], v[92:95], v[112:115], 0
  ds_read_b128 v[88:91], v125 offset:49536
  v_exp_f32 v38, v38
  v_exp_f32 v39, v39
  v_exp_f32 v40, v40
  v_exp_f32 v41, v41
  v_exp_f32 v42, v42
  v_smfmac_f32_32x32x32_bf16 v[72:87], v[96:99], v[32:39], v64
  v_exp_f32 v43, v43
  v_exp_f32 v44, v44
  v_exp_f32 v45, v45
  v_exp_f32 v46, v46
  v_exp_f32 v47, v47
  v_exp_f32 v48, v48
  v_exp_f32 v49, v49
  v_smfmac_f32_32x32x32_bf16 v[72:87], v[100:103], v[40:47], v64
  ds_read_b128 v[96:99], v3 offset:49536
  ds_read_b128 v[100:103], v4 offset:49536
  v_exp_f32 v50, v50
  v_exp_f32 v51, v51
  v_exp_f32 v52, v52
  v_exp_f32 v53, v53
  s_waitcnt lgkmcnt(2)
  v_mfma_f32_32x32x16_bf16 v[32:47], v[88:91], v[112:115], 0
  ds_read_b128 v[92:95], v125 offset:51600
  s_add_u32 m0, s54, 82560
  s_add_u32 s56, s79, 40
  s_and_b32 s56, s56, 63
  s_lshl_b32 s56, s56, 10
  s_add_u32 s56, s56, 1048576
  buffer_load_dwordx4 v1, s[40:43], s56 offen sc1 lds
  v_exp_f32 v54, v54
  v_exp_f32 v55, v55
  v_exp_f32 v56, v56
  v_exp_f32 v57, v57
  v_exp_f32 v58, v58
  v_smfmac_f32_32x32x32_bf16 v[72:87], v[104:107], v[48:55], v64
  v_exp_f32 v59, v59
  v_exp_f32 v60, v60
  v_exp_f32 v61, v61
  v_exp_f32 v62, v62
  v_exp_f32 v63, v63
  v_exp_f32 v32, v32
  v_exp_f32 v33, v33
  v_smfmac_f32_32x32x32_bf16 v[72:87], v[108:111], v[56:63], v64
  ds_read_b128 v[104:107], v3 offset:51600
  ds_read_b128 v[108:111], v4 offset:51600
  v_exp_f32 v34, v34
  v_exp_f32 v35, v35
  v_exp_f32 v36, v36
  v_exp_f32 v37, v37
  s_waitcnt lgkmcnt(2)
  v_mfma_f32_32x32x16_bf16 v[48:63], v[92:95], v[112:115], 0
  ds_read_b128 v[88:91], v125 offset:53664
  s_add_u32 m0, s54, 83584
  s_add_u32 s56, s79, 40
  s_and_b32 s56, s56, 63
  s_lshl_b32 s56, s56, 10
  s_add_u32 s56, s56, 1114112
  buffer_load_dwordx4 v1, s[40:43], s56 offen sc1 lds
  v_exp_f32 v38, v38
  v_exp_f32 v39, v39
  v_exp_f32 v40, v40
  v_exp_f32 v41, v41
  v_exp_f32 v42, v42
  v_smfmac_f32_32x32x32_bf16 v[72:87], v[96:99], v[32:39], v64
  v_exp_f32 v43, v43
  v_exp_f32 v44, v44
  v_exp_f32 v45, v45
  v_exp_f32 v46, v46
  v_exp_f32 v47, v47
  v_exp_f32 v48, v48
  v_exp_f32 v49, v49
  v_smfmac_f32_32x32x32_bf16 v[72:87], v[100:103], v[40:47], v64
  ds_read_b128 v[96:99], v3 offset:53664
  ds_read_b128 v[100:103], v4 offset:53664
  v_exp_f32 v50, v50
  v_exp_f32 v51, v51
  v_exp_f32 v52, v52
  v_exp_f32 v53, v53
  s_waitcnt lgkmcnt(2)
  v_mfma_f32_32x32x16_bf16 v[32:47], v[88:91], v[112:115], 0
  ds_read_b128 v[92:95], v125 offset:55728
  s_add_u32 m0, s54, 99072
  s_add_u32 s56, s79, 48
  s_and_b32 s56, s56, 63
  s_lshl_b32 s56, s56, 10
  s_add_u32 s56, s56, 1048576
  buffer_load_dwordx4 v1, s[40:43], s56 offen sc1 lds
  v_exp_f32 v54, v54
  v_exp_f32 v55, v55
  v_exp_f32 v56, v56
  v_exp_f32 v57, v57
  v_exp_f32 v58, v58
  v_smfmac_f32_32x32x32_bf16 v[72:87], v[104:107], v[48:55], v64
  v_exp_f32 v59, v59
  v_exp_f32 v60, v60
  v_exp_f32 v61, v61
  v_exp_f32 v62, v62
  v_exp_f32 v63, v63
  v_exp_f32 v32, v32
  v_exp_f32 v33, v33
  v_smfmac_f32_32x32x32_bf16 v[72:87], v[108:111], v[56:63], v64
  ds_read_b128 v[104:107], v3 offset:55728
  ds_read_b128 v[108:111], v4 offset:55728
  v_exp_f32 v34, v34
  v_exp_f32 v35, v35
  v_exp_f32 v36, v36
  v_exp_f32 v37, v37
  s_waitcnt lgkmcnt(2)
  v_mfma_f32_32x32x16_bf16 v[48:63], v[92:95], v[112:115], 0
  ds_read_b128 v[88:91], v125 offset:57792
  s_add_u32 m0, s54, 100096
  s_add_u32 s56, s79, 48
  s_and_b32 s56, s56, 63
  s_lshl_b32 s56, s56, 10
  s_add_u32 s56, s56, 1114112
  buffer_load_dwordx4 v1, s[40:43], s56 offen sc1 lds
  v_exp_f32 v38, v38
  v_exp_f32 v39, v39
  v_exp_f32 v40, v40
  v_exp_f32 v41, v41
  v_exp_f32 v42, v42
  v_smfmac_f32_32x32x32_bf16 v[72:87], v[96:99], v[32:39], v64
  v_exp_f32 v43, v43
  v_exp_f32 v44, v44
  v_exp_f32 v45, v45
  v_exp_f32 v46, v46
  v_exp_f32 v47, v47
  v_exp_f32 v48, v48
  v_exp_f32 v49, v49
  v_smfmac_f32_32x32x32_bf16 v[72:87], v[100:103], v[40:47], v64
  ds_read_b128 v[96:99], v3 offset:57792
  ds_read_b128 v[100:103], v4 offset:57792
  v_exp_f32 v50, v50
  v_exp_f32 v51, v51
  v_exp_f32 v52, v52
  v_exp_f32 v53, v53
  s_waitcnt lgkmcnt(2)
  v_mfma_f32_32x32x16_bf16 v[32:47], v[88:91], v[112:115], 0
  ds_read_b128 v[92:95], v125 offset:59856
  s_add_u32 m0, s54, 115584
  s_add_u32 s56, s79, 56
  s_and_b32 s56, s56, 63
  s_lshl_b32 s56, s56, 10
  s_add_u32 s56, s56, 1048576
  buffer_load_dwordx4 v1, s[40:43], s56 offen sc1 lds
  v_exp_f32 v54, v54
  v_exp_f32 v55, v55
  v_exp_f32 v56, v56
  v_exp_f32 v57, v57
  v_exp_f32 v58, v58
  v_smfmac_f32_32x32x32_bf16 v[72:87], v[104:107], v[48:55], v64
  v_exp_f32 v59, v59
  v_exp_f32 v60, v60
  v_exp_f32 v61, v61
  v_exp_f32 v62, v62
  v_exp_f32 v63, v63
  v_exp_f32 v32, v32
  v_exp_f32 v33, v33
  v_smfmac_f32_32x32x32_bf16 v[72:87], v[108:111], v[56:63], v64
  ds_read_b128 v[104:107], v3 offset:59856
  ds_read_b128 v[108:111], v4 offset:59856
  v_exp_f32 v34, v34
  v_exp_f32 v35, v35
  v_exp_f32 v36, v36
  v_exp_f32 v37, v37
  s_waitcnt lgkmcnt(2)
  v_mfma_f32_32x32x16_bf16 v[48:63], v[92:95], v[112:115], 0
  ds_read_b128 v[88:91], v125 offset:61920
  s_add_u32 m0, s54, 116608
  s_add_u32 s56, s79, 56
  s_and_b32 s56, s56, 63
  s_lshl_b32 s56, s56, 10
  s_add_u32 s56, s56, 1114112
  buffer_load_dwordx4 v1, s[40:43], s56 offen sc1 lds
  v_exp_f32 v38, v38
  v_exp_f32 v39, v39
  v_exp_f32 v40, v40
  v_exp_f32 v41, v41
  v_exp_f32 v42, v42
  v_smfmac_f32_32x32x32_bf16 v[72:87], v[96:99], v[32:39], v64
  v_exp_f32 v43, v43
  v_exp_f32 v44, v44
  v_exp_f32 v45, v45
  v_exp_f32 v46, v46
  v_exp_f32 v47, v47
  v_exp_f32 v48, v48
  v_exp_f32 v49, v49
  v_smfmac_f32_32x32x32_bf16 v[72:87], v[100:103], v[40:47], v64
  ds_read_b128 v[96:99], v3 offset:61920
  ds_read_b128 v[100:103], v4 offset:61920
  v_exp_f32 v50, v50
  v_exp_f32 v51, v51
  v_exp_f32 v52, v52
  v_exp_f32 v53, v53
  s_waitcnt lgkmcnt(2)
  v_mfma_f32_32x32x16_bf16 v[32:47], v[88:91], v[112:115], 0
  ds_read_b128 v[92:95], v125 offset:63984
  s_setprio 2
  v_exp_f32 v54, v54
  v_exp_f32 v55, v55
  v_exp_f32 v56, v56
  v_exp_f32 v57, v57
  v_exp_f32 v58, v58
  v_smfmac_f32_32x32x32_bf16 v[72:87], v[104:107], v[48:55], v64
  v_add_u32 v125, 66048, v125
  v_exp_f32 v59, v59
  v_exp_f32 v60, v60
  v_exp_f32 v61, v61
  v_exp_f32 v62, v62
  v_exp_f32 v63, v63
  v_exp_f32 v32, v32
  v_exp_f32 v33, v33
  v_smfmac_f32_32x32x32_bf16 v[72:87], v[108:111], v[56:63], v64
  ds_read_b128 v[104:107], v3 offset:63984
  ds_read_b128 v[108:111], v4 offset:63984
  v_exp_f32 v34, v34
  v_exp_f32 v35, v35
  v_exp_f32 v36, v36
  v_exp_f32 v37, v37
  s_waitcnt lgkmcnt(2)
  v_mfma_f32_32x32x16_bf16 v[48:63], v[92:95], v[112:115], 0
  ds_read_b128 v[88:91], v125 offset:0
  v_exp_f32 v38, v38
  v_exp_f32 v39, v39
  v_exp_f32 v40, v40
  v_exp_f32 v41, v41
  v_exp_f32 v42, v42
  v_smfmac_f32_32x32x32_bf16 v[72:87], v[96:99], v[32:39], v64
  v_add_u32 v3, 66048, v3
  v_add_u32 v4, 66048, v4
  v_exp_f32 v43, v43
  v_exp_f32 v44, v44
  v_exp_f32 v45, v45
  v_exp_f32 v46, v46
  v_exp_f32 v47, v47
  v_exp_f32 v48, v48
  v_exp_f32 v49, v49
  v_smfmac_f32_32x32x32_bf16 v[72:87], v[100:103], v[40:47], v64
  ds_read_b128 v[96:99], v3 offset:0
  ds_read_b128 v[100:103], v4 offset:0
  v_exp_f32 v50, v50
  v_exp_f32 v51, v51
  v_exp_f32 v52, v52
  v_exp_f32 v53, v53
  s_waitcnt lgkmcnt(2)
  v_mfma_f32_32x32x16_bf16 v[32:47], v[88:91], v[112:115], 0
  ds_read_b128 v[92:95], v125 offset:2064
  s_cmp_lg_u32 s44, 7
  s_cbranch_scc1 L_tp1_a
  s_mov_b32 s59, 12288
  buffer_load_dwordx4 v[28:31], v7, s[40:43], s59 offen sc1
L_tp1_a:
  v_exp_f32 v54, v54
  v_exp_f32 v55, v55
  v_exp_f32 v56, v56
  v_exp_f32 v57, v57
  v_exp_f32 v58, v58
  v_smfmac_f32_32x32x32_bf16 v[72:87], v[104:107], v[48:55], v64
  s_setprio 1
  v_exp_f32 v59, v59
  v_exp_f32 v60, v60
  v_exp_f32 v61, v61
  v_exp_f32 v62, v62
  v_exp_f32 v63, v63
  v_exp_f32 v32, v32
  v_exp_f32 v33, v33
  v_smfmac_f32_32x32x32_bf16 v[72:87], v[108:111], v[56:63], v64
  ds_read_b128 v[104:107], v3 offset:2064
  ds_read_b128 v[108:111], v4 offset:2064
  v_exp_f32 v34, v34
  v_exp_f32 v35, v35
  v_exp_f32 v36, v36
  v_exp_f32 v37, v37
  s_waitcnt lgkmcnt(2)
  v_mfma_f32_32x32x16_bf16 v[48:63], v[92:95], v[112:115], 0
  ds_read_b128 v[88:91], v125 offset:4128
  v_exp_f32 v38, v38
  v_exp_f32 v39, v39
  v_exp_f32 v40, v40
  v_exp_f32 v41, v41
  v_exp_f32 v42, v42
  v_smfmac_f32_32x32x32_bf16 v[72:87], v[96:99], v[32:39], v64
  v_exp_f32 v43, v43
  v_exp_f32 v44, v44
  v_exp_f32 v45, v45
  v_exp_f32 v46, v46
  v_exp_f32 v47, v47
  v_exp_f32 v48, v48
  v_exp_f32 v49, v49
  v_smfmac_f32_32x32x32_bf16 v[72:87], v[100:103], v[40:47], v64
  ds_read_b128 v[96:99], v3 offset:4128
  ds_read_b128 v[100:103], v4 offset:4128
  v_exp_f32 v50, v50
  v_exp_f32 v51, v51
  v_exp_f32 v52, v52
  v_exp_f32 v53, v53
  s_waitcnt lgkmcnt(2)
  v_mfma_f32_32x32x16_bf16 v[32:47], v[88:91], v[112:115], 0
  ds_read_b128 v[92:95], v125 offset:6192
  s_setprio 0
  v_exp_f32 v54, v54
  v_exp_f32 v55, v55
  v_exp_f32 v56, v56
  v_exp_f32 v57, v57
  v_exp_f32 v58, v58
  v_smfmac_f32_32x32x32_bf16 v[72:87], v[104:107], v[48:55], v64
  s_cmp_lg_u32 s44, 7
  s_cbranch_scc1 L_tp1_ok
  s_waitcnt vmcnt(0)
  v_xor_b32 v28, s49, v28
  v_xor_b32 v29, s49, v29
  v_xor_b32 v30, s49, v30
  v_xor_b32 v31, s49, v31
  v_or_b32 v28, v28, v29
  v_or3_b32 v28, v28, v30, v31
  v_cmp_ne_u32 vcc, 0, v28
  s_cbranch_vccnz L_tp1_retry
L_tp1_ok:
  s_waitcnt vmcnt(0)
  s_barrier
  s_setprio 3
  v_exp_f32 v59, v59
  v_exp_f32 v60, v60
  v_exp_f32 v61, v61
  v_exp_f32 v62, v62
  v_exp_f32 v63, v63
  v_exp_f32 v32, v32
  v_exp_f32 v33, v33
  v_smfmac_f32_32x32x32_bf16 v[72:87], v[108:111], v[56:63], v64
  ds_read_b128 v[104:107], v3 offset:6192
  ds_read_b128 v[108:111], v4 offset:6192
  v_exp_f32 v34, v34
  v_exp_f32 v35, v35
  v_exp_f32 v36, v36
  v_exp_f32 v37, v37
  s_waitcnt lgkmcnt(2)
  v_mfma_f32_32x32x16_bf16 v[48:63], v[92:95], v[112:115], 0
  ds_read_b128 v[88:91], v125 offset:8256
  buffer_load_dwordx4 a[0:3], v1, s[40:43], s65 offen offset:0 sc1
  v_exp_f32 v38, v38
  v_exp_f32 v39, v39
  v_exp_f32 v40, v40
  v_exp_f32 v41, v41
  v_exp_f32 v42, v42
  v_smfmac_f32_32x32x32_bf16 v[72:87], v[96:99], v[32:39], v64
  buffer_load_dwordx4 a[4:7], v1, s[40:43], s65 offen offset:1024 sc1
  v_exp_f32 v43, v43
  v_exp_f32 v44, v44
  v_exp_f32 v45, v45
  v_exp_f32 v46, v46
  v_exp_f32 v47, v47
  v_exp_f32 v48, v48
  v_exp_f32 v49, v49
  v_smfmac_f32_32x32x32_bf16 v[72:87], v[100:103], v[40:47], v64
  ds_read_b128 v[96:99], v3 offset:8256
  ds_read_b128 v[100:103], v4 offset:8256
  v_exp_f32 v50, v50
  v_exp_f32 v51, v51
  v_exp_f32 v52, v52
  v_exp_f32 v53, v53
  s_waitcnt lgkmcnt(2)
  v_mfma_f32_32x32x16_bf16 v[32:47], v[88:91], v[112:115], 0
  ds_read_b128 v[92:95], v125 offset:10320
  buffer_load_dwordx4 a[8:11], v1, s[40:43], s65 offen offset:2048 sc1
  v_exp_f32 v54, v54
  v_exp_f32 v55, v55
  v_exp_f32 v56, v56
  v_exp_f32 v57, v57
  v_exp_f32 v58, v58
  v_smfmac_f32_32x32x32_bf16 v[72:87], v[104:107], v[48:55], v64
  s_add_u32 s57, s66, 16384
  buffer_load_dwordx4 v[8:11], v2, s[40:43], s57 offen offset:0 sc1
  v_exp_f32 v59, v59
  v_exp_f32 v60, v60
  v_exp_f32 v61, v61
  v_exp_f32 v62, v62
  v_exp_f32 v63, v63
  v_exp_f32 v32, v32
  v_exp_f32 v33, v33
  v_smfmac_f32_32x32x32_bf16 v[72:87], v[108:111], v[56:63], v64
  ds_read_b128 v[104:107], v3 offset:10320
  ds_read_b128 v[108:111], v4 offset:10320
  v_exp_f32 v34, v34
  v_exp_f32 v35, v35
  v_exp_f32 v36, v36
  v_exp_f32 v37, v37
  s_waitcnt lgkmcnt(2)
  v_mfma_f32_32x32x16_bf16 v[48:63], v[92:95], v[112:115], 0
  ds_read_b128 v[88:91], v125 offset:12384
  s_add_u32 s57, s66, 16384
  buffer_load_dwordx4 v[12:15], v2, s[40:43], s57 offen offset:256 sc1
  v_exp_f32 v38, v38
  v_exp_f32 v39, v39
  v_exp_f32 v40, v40
  v_exp_f32 v41, v41
  v_exp_f32 v42, v42
  v_smfmac_f32_32x32x32_bf16 v[72:87], v[96:99], v[32:39], v64
  buffer_load_dwordx4 a[12:15], v1, s[40:43], s65 offen offset:3072 sc1
  s_add_u32 s65, s65, 4096
  v_exp_f32 v43, v43
  v_exp_f32 v44, v44
  v_exp_f32 v45, v45
  v_exp_f32 v46, v46
  v_exp_f32 v47, v47
  v_exp_f32 v48, v48
  v_exp_f32 v49, v49
  v_smfmac_f32_32x32x32_bf16 v[72:87], v[100:103], v[40:47], v64
  ds_read_b128 v[96:99], v3 offset:12384
  ds_read_b128 v[100:103], v4 offset:12384
  v_exp_f32 v50, v50
  v_exp_f32 v51, v51
  v_exp_f32 v52, v52
  v_exp_f32 v53, v53
  s_waitcnt lgkmcnt(2)
  v_mfma_f32_32x32x16_bf16 v[32:47], v[88:91], v[112:115], 0
  ds_read_b128 v[92:95], v125 offset:14448
  buffer_load_dwordx4 a[16:19], v1, s[40:43], s65 offen offset:0 sc1
  v_exp_f32 v54, v54
  v_exp_f32 v55, v55
  v_exp_f32 v56, v56
  v_exp_f32 v57, v57
  v_exp_f32 v58, v58
  v_smfmac_f32_32x32x32_bf16 v[72:87], v[104:107], v[48:55], v64
  buffer_load_dwordx4 a[20:23], v1, s[40:43], s65 offen offset:1024 sc1
  v_exp_f32 v59, v59
  v_exp_f32 v60, v60
  v_exp_f32 v61, v61
  v_exp_f32 v62, v62
  v_exp_f32 v63, v63
  v_exp_f32 v32, v32
  v_exp_f32 v33, v33
  v_smfmac_f32_32x32x32_bf16 v[72:87], v[108:111], v[56:63], v64
  ds_read_b128 v[104:107], v3 offset:14448
  ds_read_b128 v[108:111], v4 offset:14448
  v_exp_f32 v34, v34
  v_exp_f32 v35, v35
  v_exp_f32 v36, v36
  v_exp_f32 v37, v37
  s_waitcnt lgkmcnt(2)
  v_mfma_f32_32x32x16_bf16 v[48:63], v[92:95], v[112:115], 0
  ds_read_b128 v[88:91], v125 offset:16512
  s_add_u32 s57, s66, 16384
  buffer_load_dwordx4 v[16:19], v2, s[40:43], s57 offen offset:1024 sc1
  v_exp_f32 v38, v38
  v_exp_f32 v39, v39
  v_exp_f32 v40, v40
  v_exp_f32 v41, v41
  v_exp_f32 v42, v42
  v_smfmac_f32_32x32x32_bf16 v[72:87], v[96:99], v[32:39], v64
  s_add_u32 s57, s66, 16384
  buffer_load_dwordx4 v[20:23], v2, s[40:43], s57 offen offset:1280 sc1
  v_exp_f32 v43, v43
  v_exp_f32 v44, v44
  v_exp_f32 v45, v45
  v_exp_f32 v46, v46
  v_exp_f32 v47, v47
  v_exp_f32 v48, v48
  v_exp_f32 v49, v49
  v_smfmac_f32_32x32x32_bf16 v[72:87], v[100:103], v[40:47], v64
  ds_read_b128 v[96:99], v3 offset:16512
  ds_read_b128 v[100:103], v4 offset:16512
  v_exp_f32 v50, v50
  v_exp_f32 v51, v51
  v_exp_f32 v52, v52
  v_exp_f32 v53, v53
  s_waitcnt lgkmcnt(2)
  v_mfma_f32_32x32x16_bf16 v[32:47], v[88:91], v[112:115], 0
  ds_read_b128 v[92:95], v125 offset:18576
  buffer_load_dwordx4 a[24:27], v1, s[40:43], s65 offen offset:2048 sc1
  v_exp_f32 v54, v54
  v_exp_f32 v55, v55
  v_exp_f32 v56, v56
  v_exp_f32 v57, v57
  v_exp_f32 v58, v58
  v_smfmac_f32_32x32x32_bf16 v[72:87], v[104:107], v[48:55], v64
  buffer_load_dwordx4 a[28:31], v1, s[40:43], s65 offen offset:3072 sc1
  s_add_u32 s65, s65, 4096
  v_exp_f32 v59, v59
  v_exp_f32 v60, v60
  v_exp_f32 v61, v61
  v_exp_f32 v62, v62
  v_exp_f32 v63, v63
  v_exp_f32 v32, v32
  v_exp_f32 v33, v33
  v_smfmac_f32_32x32x32_bf16 v[72:87], v[108:111], v[56:63], v64
  ds_read_b128 v[104:107], v3 offset:18576
  ds_read_b128 v[108:111], v4 offset:18576
  v_exp_f32 v34, v34
  v_exp_f32 v35, v35
  v_exp_f32 v36, v36
  v_exp_f32 v37, v37
  s_waitcnt lgkmcnt(2)
  v_mfma_f32_32x32x16_bf16 v[48:63], v[92:95], v[112:115], 0
  ds_read_b128 v[88:91], v125 offset:20640
  buffer_load_dwordx4 a[32:35], v1, s[40:43], s65 offen offset:0 sc1
  v_exp_f32 v38, v38
  v_exp_f32 v39, v39
  v_exp_f32 v40, v40
  v_exp_f32 v41, v41
  v_exp_f32 v42, v42
  v_smfmac_f32_32x32x32_bf16 v[72:87], v[96:99], v[32:39], v64
  s_cmp_eq_u32 s44, 7
  s_cselect_b32 m0, 163840, s63
  s_nop 0
  buffer_load_dwordx4 v1, s[40:43], s66 offen offset:0 sc1 lds
  v_exp_f32 v43, v43
  v_exp_f32 v44, v44
  v_exp_f32 v45, v45
  v_exp_f32 v46, v46
  v_exp_f32 v47, v47
  v_exp_f32 v48, v48
  v_exp_f32 v49, v49
  v_smfmac_f32_32x32x32_bf16 v[72:87], v[100:103], v[40:47], v64
  ds_read_b128 v[96:99], v3 offset:20640
  ds_read_b128 v[100:103], v4 offset:20640
  v_exp_f32 v50, v50
  v_exp_f32 v51, v51
  v_exp_f32 v52, v52
  v_exp_f32 v53, v53
  s_waitcnt lgkmcnt(2)
  v_mfma_f32_32x32x16_bf16 v[32:47], v[88:91], v[112:115], 0
  ds_read_b128 v[92:95], v125 offset:22704
  s_cmp_eq_u32 s44, 7
  s_cselect_b32 m0, 163840, s63
  s_nop 0
  buffer_load_dwordx4 v1, s[40:43], s66 offen offset:1024 sc1 lds
  v_exp_f32 v54, v54
  v_exp_f32 v55, v55
  v_exp_f32 v56, v56
  v_exp_f32 v57, v57
  v_exp_f32 v58, v58
  v_smfmac_f32_32x32x32_bf16 v[72:87], v[104:107], v[48:55], v64
  buffer_load_dwordx4 a[36:39], v1, s[40:43], s65 offen offset:1024 sc1
  v_exp_f32 v59, v59
  v_exp_f32 v60, v60
  v_exp_f32 v61, v61
  v_exp_f32 v62, v62
  v_exp_f32 v63, v63
  v_exp_f32 v32, v32
  v_exp_f32 v33, v33
  v_smfmac_f32_32x32x32_bf16 v[72:87], v[108:111], v[56:63], v64
  ds_read_b128 v[104:107], v3 offset:22704
  ds_read_b128 v[108:111], v4 offset:22704
  v_exp_f32 v34, v34
  v_exp_f32 v35, v35
  v_exp_f32 v36, v36
  v_exp_f32 v37, v37
  s_waitcnt lgkmcnt(2)
  v_mfma_f32_32x32x16_bf16 v[48:63], v[92:95], v[112:115], 0
  ds_read_b128 v[88:91], v125 offset:24768
  buffer_load_dwordx4 a[40:43], v1, s[40:43], s65 offen offset:2048 sc1
  v_exp_f32 v38, v38
  v_exp_f32 v39, v39
  v_exp_f32 v40, v40
  v_exp_f32 v41, v41
  v_exp_f32 v42, v42
  v_smfmac_f32_32x32x32_bf16 v[72:87], v[96:99], v[32:39], v64
  v_exp_f32 v43, v43
  v_exp_f32 v44, v44
  v_exp_f32 v45, v45
  v_exp_f32 v46, v46
  v_exp_f32 v47, v47
  v_exp_f32 v48, v48
  v_exp_f32 v49, v49
  v_smfmac_f32_32x32x32_bf16 v[72:87], v[100:103], v[40:47], v64
  ds_read_b128 v[96:99], v3 offset:24768
  ds_read_b128 v[100:103], v4 offset:24768
  v_exp_f32 v50, v50
  v_exp_f32 v51, v51
  v_exp_f32 v52, v52
  v_exp_f32 v53, v53
  s_waitcnt lgkmcnt(2)
  v_mfma_f32_32x32x16_bf16 v[32:47], v[88:91], v[112:115], 0
  ds_read_b128 v[92:95], v125 offset:26832
  buffer_load_dwordx4 a[44:47], v1, s[40:43], s65 offen offset:3072 sc1
  s_add_u32 s65, s65, 4096
  v_exp_f32 v54, v54
  v_exp_f32 v55, v55
  v_exp_f32 v56, v56
  v_exp_f32 v57, v57
  v_exp_f32 v58, v58
  v_smfmac_f32_32x32x32_bf16 v[72:87], v[104:107], v[48:55], v64
  s_cmp_eq_u32 s44, 7
  s_cselect_b32 m0, 163840, s63
  s_nop 0
  buffer_load_dwordx4 v1, s[40:43], s66 offen offset:2048 sc1 lds
  v_exp_f32 v59, v59
  v_exp_f32 v60, v60
  v_exp_f32 v61, v61
  v_exp_f32 v62, v62
  v_exp_f32 v63, v63
  v_exp_f32 v32, v32
  v_exp_f32 v33, v33
  v_smfmac_f32_32x32x32_bf16 v[72:87], v[108:111], v[56:63], v64
  ds_read_b128 v[104:107], v3 offset:26832
  ds_read_b128 v[108:111], v4 offset:26832
  v_exp_f32 v34, v34
  v_exp_f32 v35, v35
  v_exp_f32 v36, v36
  v_exp_f32 v37, v37
  s_waitcnt lgkmcnt(2)
  v_mfma_f32_32x32x16_bf16 v[48:63], v[92:95], v[112:115], 0
  ds_read_b128 v[88:91], v125 offset:28896
  s_cmp_eq_u32 s44, 7
  s_cselect_b32 m0, 163840, s63
  s_nop 0
  buffer_load_dwordx4 v1, s[40:43], s66 offen offset:3072 sc1 lds
  v_exp_f32 v38, v38
  v_exp_f32 v39, v39
  v_exp_f32 v40, v40
  v_exp_f32 v41, v41
  v_exp_f32 v42, v42
  v_smfmac_f32_32x32x32_bf16 v[72:87], v[96:99], v[32:39], v64
  buffer_load_dwordx4 a[48:51], v1, s[40:43], s65 offen offset:0 sc1
  v_exp_f32 v43, v43
  v_exp_f32 v44, v44
  v_exp_f32 v45, v45
  v_exp_f32 v46, v46
  v_exp_f32 v47, v47
  v_exp_f32 v48, v48
  v_exp_f32 v49, v49
  v_smfmac_f32_32x32x32_bf16 v[72:87], v[100:103], v[40:47], v64
  ds_read_b128 v[96:99], v3 offset:28896
  ds_read_b128 v[100:103], v4 offset:28896
  v_exp_f32 v50, v50
  v_exp_f32 v51, v51
  v_exp_f32 v52, v52
  v_exp_f32 v53, v53
  s_waitcnt lgkmcnt(2)
  v_mfma_f32_32x32x16_bf16 v[32:47], v[88:91], v[112:115], 0
  ds_read_b128 v[92:95], v125 offset:30960
  buffer_load_dwordx4 a[52:55], v1, s[40:43], s65 offen offset:1024 sc1
  v_exp_f32 v54, v54
  v_exp_f32 v55, v55
  v_exp_f32 v56, v56
  v_exp_f32 v57, v57
  v_exp_f32 v58, v58
  v_smfmac_f32_32x32x32_bf16 v[72:87], v[104:107], v[48:55], v64
  buffer_load_dwordx4 a[56:59], v1, s[40:43], s65 offen offset:2048 sc1
  v_exp_f32 v59, v59
  v_exp_f32 v60, v60
  v_exp_f32 v61, v61
  v_exp_f32 v62, v62
  v_exp_f32 v63, v63
  v_exp_f32 v32, v32
  v_exp_f32 v33, v33
  v_smfmac_f32_32x32x32_bf16 v[72:87], v[108:111], v[56:63], v64
  ds_read_b128 v[104:107], v3 offset:30960
  ds_read_b128 v[108:111], v4 offset:30960
  v_exp_f32 v34, v34
  v_exp_f32 v35, v35
  v_exp_f32 v36, v36
  v_exp_f32 v37, v37
  s_waitcnt lgkmcnt(2)
  v_mfma_f32_32x32x16_bf16 v[48:63], v[92:95], v[112:115], 0
  ds_read_b128 v[88:91], v125 offset:33024
  s_add_u32 m0, s22, 0
  s_add_u32 s57, s6, 0
  buffer_load_dwordx4 v1, s[40:43], s57 offen offset:0 sc1 lds
  v_exp_f32 v38, v38
  v_exp_f32 v39, v39
  v_exp_f32 v40, v40
  v_exp_f32 v41, v41
  v_exp_f32 v42, v42
  v_smfmac_f32_32x32x32_bf16 v[72:87], v[96:99], v[32:39], v64
  s_add_u32 m0, s22, 0
  s_add_u32 s57, s6, 0
  buffer_load_dwordx4 v1, s[40:43], s57 offen offset:1024 sc1 lds
  v_exp_f32 v43, v43
  v_exp_f32 v44, v44
  v_exp_f32 v45, v45
  v_exp_f32 v46, v46
  v_exp_f32 v47, v47
  v_exp_f32 v48, v48
  v_exp_f32 v49, v49
  v_smfmac_f32_32x32x32_bf16 v[72:87], v[100:103], v[40:47], v64
  ds_read_b128 v[96:99], v3 offset:33024
  ds_read_b128 v[100:103], v4 offset:33024
  v_exp_f32 v50, v50
  v_exp_f32 v51, v51
  v_exp_f32 v52, v52
  v_exp_f32 v53, v53
  s_waitcnt lgkmcnt(2)
  v_mfma_f32_32x32x16_bf16 v[32:47], v[88:91], v[112:115], 0
  ds_read_b128 v[92:95], v125 offset:35088
  buffer_load_dwordx4 a[60:63], v1, s[40:43], s65 offen offset:3072 sc1
  s_add_u32 s65, s65, 4096
  v_exp_f32 v54, v54
  v_exp_f32 v55, v55
  v_exp_f32 v56, v56
  v_exp_f32 v57, v57
  v_exp_f32 v58, v58
  v_smfmac_f32_32x32x32_bf16 v[72:87], v[104:107], v[48:55], v64
  buffer_load_dwordx4 a[64:67], v1, s[40:43], s65 offen offset:0 sc1
  v_exp_f32 v59, v59
  v_exp_f32 v60, v60
  v_exp_f32 v61, v61
  v_exp_f32 v62, v62
  v_exp_f32 v63, v63
  v_exp_f32 v32, v32
  v_exp_f32 v33, v33
  v_smfmac_f32_32x32x32_bf16 v[72:87], v[108:111], v[56:63], v64
  ds_read_b128 v[104:107], v3 offset:35088
  ds_read_b128 v[108:111], v4 offset:35088
  v_exp_f32 v34, v34
  v_exp_f32 v35, v35
  v_exp_f32 v36, v36
  v_exp_f32 v37, v37
  s_waitcnt lgkmcnt(2)
  v_mfma_f32_32x32x16_bf16 v[48:63], v[92:95], v[112:115], 0
  ds_read_b128 v[88:91], v125 offset:37152
  buffer_load_dwordx4 a[68:71], v1, s[40:43], s65 offen offset:1024 sc1
  v_exp_f32 v38, v38
  v_exp_f32 v39, v39
  v_exp_f32 v40, v40
  v_exp_f32 v41, v41
  v_exp_f32 v42, v42
  v_smfmac_f32_32x32x32_bf16 v[72:87], v[96:99], v[32:39], v64
  s_add_u32 m0, s22, 0
  s_add_u32 s57, s6, 0
  buffer_load_dwordx4 v1, s[40:43], s57 offen offset:2048 sc1 lds
  v_exp_f32 v43, v43
  v_exp_f32 v44, v44
  v_exp_f32 v45, v45
  v_exp_f32 v46, v46
  v_exp_f32 v47, v47
  v_exp_f32 v48, v48
  v_exp_f32 v49, v49
  v_smfmac_f32_32x32x32_bf16 v[72:87], v[100:103], v[40:47], v64
  ds_read_b128 v[96:99], v3 offset:37152
  ds_read_b128 v[100:103], v4 offset:37152
  v_exp_f32 v50, v50
  v_exp_f32 v51, v51
  v_exp_f32 v52, v52
  v_exp_f32 v53, v53
  s_waitcnt lgkmcnt(2)
  v_mfma_f32_32x32x16_bf16 v[32:47], v[88:91], v[112:115], 0
  ds_read_b128 v[92:95], v125 offset:39216
  s_add_u32 m0, s22, 0
  s_add_u32 s57, s6, 0
  buffer_load_dwordx4 v1, s[40:43], s57 offen offset:3072 sc1 lds
  v_exp_f32 v54, v54
  v_exp_f32 v55, v55
  v_exp_f32 v56, v56
  v_exp_f32 v57, v57
  v_exp_f32 v58, v58
  v_smfmac_f32_32x32x32_bf16 v[72:87], v[104:107], v[48:55], v64
  buffer_load_dwordx4 a[72:75], v1, s[40:43], s65 offen offset:2048 sc1
  v_exp_f32 v59, v59
  v_exp_f32 v60, v60
  v_exp_f32 v61, v61
  v_exp_f32 v62, v62
  v_exp_f32 v63, v63
  v_exp_f32 v32, v32
  v_exp_f32 v33, v33
  v_smfmac_f32_32x32x32_bf16 v[72:87], v[108:111], v[56:63], v64
  ds_read_b128 v[104:107], v3 offset:39216
  ds_read_b128 v[108:111], v4 offset:39216
  v_exp_f32 v34, v34
  v_exp_f32 v35, v35
  v_exp_f32 v36, v36
  v_exp_f32 v37, v37
  s_waitcnt lgkmcnt(2)
  v_mfma_f32_32x32x16_bf16 v[48:63], v[92:95], v[112:115], 0
  ds_read_b128 v[88:91], v125 offset:41280
  buffer_load_dwordx4 a[76:79], v1, s[40:43], s65 offen offset:3072 sc1
  s_add_u32 s65, s65, 4096
  v_exp_f32 v38, v38
  v_exp_f32 v39, v39
  v_exp_f32 v40, v40
  v_exp_f32 v41, v41
  v_exp_f32 v42, v42
  v_smfmac_f32_32x32x32_bf16 v[72:87], v[96:99], v[32:39], v64
  buffer_load_dwordx4 a[80:83], v1, s[40:43], s65 offen offset:0 sc1
  v_exp_f32 v43, v43
  v_exp_f32 v44, v44
  v_exp_f32 v45, v45
  v_exp_f32 v46, v46
  v_exp_f32 v47, v47
  v_exp_f32 v48, v48
  v_exp_f32 v49, v49
  v_smfmac_f32_32x32x32_bf16 v[72:87], v[100:103], v[40:47], v64
  ds_read_b128 v[96:99], v3 offset:41280
  ds_read_b128 v[100:103], v4 offset:41280
  v_exp_f32 v50, v50
  v_exp_f32 v51, v51
  v_exp_f32 v52, v52
  v_exp_f32 v53, v53
  s_waitcnt lgkmcnt(2)
  v_mfma_f32_32x32x16_bf16 v[32:47], v[88:91], v[112:115], 0
  ds_read_b128 v[92:95], v125 offset:43344
  s_add_u32 m0, s22, 4096
  s_add_u32 s57, s6, 4096
  buffer_load_dwordx4 v1, s[40:43], s57 offen offset:0 sc1 lds
  v_exp_f32 v54, v54
  v_exp_f32 v55, v55
  v_exp_f32 v56, v56
  v_exp_f32 v57, v57
  v_exp_f32 v58, v58
  v_smfmac_f32_32x32x32_bf16 v[72:87], v[104:107], v[48:55], v64
  v_exp_f32 v59, v59
  v_exp_f32 v60, v60
  v_exp_f32 v61, v61
  v_exp_f32 v62, v62
  v_exp_f32 v63, v63
  v_exp_f32 v32, v32
  v_exp_f32 v33, v33
  v_smfmac_f32_32x32x32_bf16 v[72:87], v[108:111], v[56:63], v64
  ds_read_b128 v[104:107], v3 offset:43344
  ds_read_b128 v[108:111], v4 offset:43344
  v_exp_f32 v34, v34
  v_exp_f32 v35, v35
  v_exp_f32 v36, v36
  v_exp_f32 v37, v37
  s_waitcnt lgkmcnt(2)
  v_mfma_f32_32x32x16_bf16 v[48:63], v[92:95], v[112:115], 0
  ds_read_b128 v[88:91], v125 offset:45408
  s_add_u32 m0, s22, 4096
  s_add_u32 s57, s6, 4096
  buffer_load_dwordx4 v1, s[40:43], s57 offen offset:1024 sc1 lds
  v_exp_f32 v38, v38
  v_exp_f32 v39, v39
  v_exp_f32 v40, v40
  v_exp_f32 v41, v41
  v_exp_f32 v42, v42
  v_smfmac_f32_32x32x32_bf16 v[72:87], v[96:99], v[32:39], v64
  buffer_load_dwordx4 a[84:87], v1, s[40:43], s65 offen offset:1024 sc1
  v_exp_f32 v43, v43
  v_exp_f32 v44, v44
  v_exp_f32 v45, v45
  v_exp_f32 v46, v46
  v_exp_f32 v47, v47
  v_exp_f32 v48, v48
  v_exp_f32 v49, v49
  v_smfmac_f32_32x32x32_bf16 v[72:87], v[100:103], v[40:47], v64
  ds_read_b128 v[96:99], v3 offset:45408
  ds_read_b128 v[100:103], v4 offset:45408
  v_exp_f32 v50, v50
  v_exp_f32 v51, v51
  v_exp_f32 v52, v52
  v_exp_f32 v53, v53
  s_waitcnt lgkmcnt(2)
  v_mfma_f32_32x32x16_bf16 v[32:47], v[88:91], v[112:115], 0
  ds_read_b128 v[92:95], v125 offset:47472
  buffer_load_dwordx4 a[88:91], v1, s[40:43], s65 offen offset:2048 sc1
  v_exp_f32 v54, v54
  v_exp_f32 v55, v55
  v_exp_f32 v56, v56
  v_exp_f32 v57, v57
  v_exp_f32 v58, v58
  v_smfmac_f32_32x32x32_bf16 v[72:87], v[104:107], v[48:55], v64
  buffer_load_dwordx4 a[92:95], v1, s[40:43], s65 offen offset:3072 sc1
  s_add_u32 s65, s65, 4096
  v_exp_f32 v59, v59
  v_exp_f32 v60, v60
  v_exp_f32 v61, v61
  v_exp_f32 v62, v62
  v_exp_f32 v63, v63
  v_exp_f32 v32, v32
  v_exp_f32 v33, v33
  v_smfmac_f32_32x32x32_bf16 v[72:87], v[108:111], v[56:63], v64
  ds_read_b128 v[104:107], v3 offset:47472
  ds_read_b128 v[108:111], v4 offset:47472
  v_exp_f32 v34, v34
  v_exp_f32 v35, v35
  v_exp_f32 v36, v36
  v_exp_f32 v37, v37
  s_waitcnt lgkmcnt(2)
  v_mfma_f32_32x32x16_bf16 v[48:63], v[92:95], v[112:115], 0
  ds_read_b128 v[88:91], v125 offset:49536
  s_add_u32 m0, s22, 4096
  s_add_u32 s57, s6, 4096
  buffer_load_dwordx4 v1, s[40:43], s57 offen offset:2048 sc1 lds
  v_exp_f32 v38, v38
  v_exp_f32 v39, v39
  v_exp_f32 v40, v40
  v_exp_f32 v41, v41
  v_exp_f32 v42, v42
  v_smfmac_f32_32x32x32_bf16 v[72:87], v[96:99], v[32:39], v64
  s_add_u32 m0, s22, 4096
  s_add_u32 s57, s6, 4096
  buffer_load_dwordx4 v1, s[40:43], s57 offen offset:3072 sc1 lds
  v_exp_f32 v43, v43
  v_exp_f32 v44, v44
  v_exp_f32 v45, v45
  v_exp_f32 v46, v46
  v_exp_f32 v47, v47
  v_exp_f32 v48, v48
  v_exp_f32 v49, v49
  v_smfmac_f32_32x32x32_bf16 v[72:87], v[100:103], v[40:47], v64
  ds_read_b128 v[96:99], v3 offset:49536
  ds_read_b128 v[100:103], v4 offset:49536
  v_exp_f32 v50, v50
  v_exp_f32 v51, v51
  v_exp_f32 v52, v52
  v_exp_f32 v53, v53
  s_waitcnt lgkmcnt(2)
  v_mfma_f32_32x32x16_bf16 v[32:47], v[88:91], v[112:115], 0
  ds_read_b128 v[92:95], v125 offset:51600
  buffer_load_dwordx4 a[96:99], v1, s[40:43], s65 offen offset:0 sc1
  v_exp_f32 v54, v54
  v_exp_f32 v55, v55
  v_exp_f32 v56, v56
  v_exp_f32 v57, v57
  v_exp_f32 v58, v58
  v_smfmac_f32_32x32x32_bf16 v[72:87], v[104:107], v[48:55], v64
  buffer_load_dwordx4 a[100:103], v1, s[40:43], s65 offen offset:1024 sc1
  v_exp_f32 v59, v59
  v_exp_f32 v60, v60
  v_exp_f32 v61, v61
  v_exp_f32 v62, v62
  v_exp_f32 v63, v63
  v_exp_f32 v32, v32
  v_exp_f32 v33, v33
  v_smfmac_f32_32x32x32_bf16 v[72:87], v[108:111], v[56:63], v64
  ds_read_b128 v[104:107], v3 offset:51600
  ds_read_b128 v[108:111], v4 offset:51600
  v_exp_f32 v34, v34
  v_exp_f32 v35, v35
  v_exp_f32 v36, v36
  v_exp_f32 v37, v37
  s_waitcnt lgkmcnt(2)
  v_mfma_f32_32x32x16_bf16 v[48:63], v[92:95], v[112:115], 0
  ds_read_b128 v[88:91], v125 offset:53664
  buffer_load_dwordx4 a[104:107], v1, s[40:43], s65 offen offset:2048 sc1
  v_exp_f32 v38, v38
  v_exp_f32 v39, v39
  v_exp_f32 v40, v40
  v_exp_f32 v41, v41
  v_exp_f32 v42, v42
  v_smfmac_f32_32x32x32_bf16 v[72:87], v[96:99], v[32:39], v64
  s_mov_b32 exec_lo, 0x7fffff
  s_mov_b32 exec_hi, 0x0
  buffer_load_dword v126, v5, s[40:43], 0 offen
  s_mov_b64 exec, -1
  v_exp_f32 v43, v43
  v_exp_f32 v44, v44
  v_exp_f32 v45, v45
  v_exp_f32 v46, v46
  v_exp_f32 v47, v47
  v_exp_f32 v48, v48
  v_exp_f32 v49, v49
  v_smfmac_f32_32x32x32_bf16 v[72:87], v[100:103], v[40:47], v64
  ds_read_b128 v[96:99], v3 offset:53664
  ds_read_b128 v[100:103], v4 offset:53664
  v_exp_f32 v50, v50
  v_exp_f32 v51, v51
  v_exp_f32 v52, v52
  v_exp_f32 v53, v53
  s_waitcnt lgkmcnt(2)
  v_mfma_f32_32x32x16_bf16 v[32:47], v[88:91], v[112:115], 0
  ds_read_b128 v[92:95], v125 offset:55728
  s_setprio 2
  v_and_b32 v124, 15, v0
  v_lshlrev_b32 v124, 10, v124
  v_lshrrev_b32 v6, 4, v0
  v_lshl_add_u32 v124, v6, 3, v124
  s_and_b32 s56, s44, 3
  s_lshl_b32 s56, s56, 14
  s_lshl_b32 s57, s51, 15
  s_add_u32 s56, s56, s57
  s_lshl_b32 s57, s48, 7
  s_add_u32 s56, s56, s57
  s_lshr_b32 s57, s44, 2
  s_lshl_b32 s57, s57, 6
  s_add_u32 s56, s56, s57
  buffer_load_dwordx2 v[24:25], v124, s[8:11], s56 offen
  buffer_load_dwordx2 v[26:27], v124, s[8:11], s56 offen offset:32
  v_exp_f32 v54, v54
  v_exp_f32 v55, v55
  v_exp_f32 v56, v56
  v_exp_f32 v57, v57
  v_exp_f32 v58, v58
  v_smfmac_f32_32x32x32_bf16 v[72:87], v[104:107], v[48:55], v64
  buffer_load_dwordx4 a[108:111], v1, s[40:43], s65 offen offset:3072 sc1
  s_add_u32 s65, s65, 4096
  v_exp_f32 v59, v59
  v_exp_f32 v60, v60
  v_exp_f32 v61, v61
  v_exp_f32 v62, v62
  v_exp_f32 v63, v63
  v_exp_f32 v32, v32
  v_exp_f32 v33, v33
  v_smfmac_f32_32x32x32_bf16 v[72:87], v[108:111], v[56:63], v64
  ds_read_b128 v[104:107], v3 offset:55728
  ds_read_b128 v[108:111], v4 offset:55728
  v_exp_f32 v34, v34
  v_exp_f32 v35, v35
  v_exp_f32 v36, v36
  v_exp_f32 v37, v37
  s_waitcnt lgkmcnt(2)
  v_mfma_f32_32x32x16_bf16 v[48:63], v[92:95], v[112:115], 0
  ds_read_b128 v[88:91], v125 offset:57792
  buffer_load_dwordx4 a[112:115], v1, s[40:43], s65 offen offset:0 sc1
  v_exp_f32 v38, v38
  v_exp_f32 v39, v39
  v_exp_f32 v40, v40
  v_exp_f32 v41, v41
  v_exp_f32 v42, v42
  v_smfmac_f32_32x32x32_bf16 v[72:87], v[96:99], v[32:39], v64
  buffer_load_dwordx4 a[116:119], v1, s[40:43], s65 offen offset:1024 sc1
  v_exp_f32 v43, v43
  v_exp_f32 v44, v44
  v_exp_f32 v45, v45
  v_exp_f32 v46, v46
  v_exp_f32 v47, v47
  v_exp_f32 v48, v48
  v_exp_f32 v49, v49
  v_smfmac_f32_32x32x32_bf16 v[72:87], v[100:103], v[40:47], v64
  ds_read_b128 v[96:99], v3 offset:57792
  ds_read_b128 v[100:103], v4 offset:57792
  v_exp_f32 v50, v50
  v_exp_f32 v51, v51
  v_exp_f32 v52, v52
  v_exp_f32 v53, v53
  s_waitcnt lgkmcnt(2)
  v_mfma_f32_32x32x16_bf16 v[32:47], v[88:91], v[112:115], 0
  ds_read_b128 v[92:95], v125 offset:59856
  buffer_load_dwordx4 a[120:123], v1, s[40:43], s65 offen offset:2048 sc1
  v_exp_f32 v54, v54
  v_exp_f32 v55, v55
  v_exp_f32 v56, v56
  v_exp_f32 v57, v57
  v_exp_f32 v58, v58
  v_smfmac_f32_32x32x32_bf16 v[72:87], v[104:107], v[48:55], v64
  buffer_load_dwordx4 a[124:127], v1, s[40:43], s65 offen offset:3072 sc1
  s_add_u32 s65, s65, 4096
  v_exp_f32 v59, v59
  v_exp_f32 v60, v60
  v_exp_f32 v61, v61
  v_exp_f32 v62, v62
  v_exp_f32 v63, v63
  v_exp_f32 v32, v32
  v_exp_f32 v33, v33
  v_smfmac_f32_32x32x32_bf16 v[72:87], v[108:111], v[56:63], v64
  ds_read_b128 v[104:107], v3 offset:59856
  ds_read_b128 v[108:111], v4 offset:59856
  v_exp_f32 v34, v34
  v_exp_f32 v35, v35
  v_exp_f32 v36, v36
  v_exp_f32 v37, v37
  s_waitcnt lgkmcnt(2)
  v_mfma_f32_32x32x16_bf16 v[48:63], v[92:95], v[112:115], 0
  ds_read_b128 v[88:91], v125 offset:61920
  v_exp_f32 v38, v38
  v_exp_f32 v39, v39
  v_exp_f32 v40, v40
  v_exp_f32 v41, v41
  v_exp_f32 v42, v42
  v_smfmac_f32_32x32x32_bf16 v[72:87], v[96:99], v[32:39], v64
  v_exp_f32 v43, v43
  v_exp_f32 v44, v44
  v_exp_f32 v45, v45
  v_exp_f32 v46, v46
  v_exp_f32 v47, v47
  v_exp_f32 v48, v48
  v_exp_f32 v49, v49
  v_smfmac_f32_32x32x32_bf16 v[72:87], v[100:103], v[40:47], v64
  ds_read_b128 v[96:99], v3 offset:61920
  ds_read_b128 v[100:103], v4 offset:61920
  v_exp_f32 v50, v50
  v_exp_f32 v51, v51
  v_exp_f32 v52, v52
  v_exp_f32 v53, v53
  s_waitcnt lgkmcnt(2)
  v_mfma_f32_32x32x16_bf16 v[32:47], v[88:91], v[112:115], 0
  ds_read_b128 v[92:95], v125 offset:63984
  v_exp_f32 v54, v54
  v_exp_f32 v55, v55
  v_exp_f32 v56, v56
  v_exp_f32 v57, v57
  v_exp_f32 v58, v58
  v_smfmac_f32_32x32x32_bf16 v[72:87], v[104:107], v[48:55], v64
  v_exp_f32 v59, v59
  v_exp_f32 v60, v60
  v_exp_f32 v61, v61
  v_exp_f32 v62, v62
  v_exp_f32 v63, v63
  v_exp_f32 v32, v32
  v_exp_f32 v33, v33
  v_smfmac_f32_32x32x32_bf16 v[72:87], v[108:111], v[56:63], v64
  ds_read_b128 v[104:107], v3 offset:63984
  ds_read_b128 v[108:111], v4 offset:63984
  v_exp_f32 v34, v34
  v_exp_f32 v35, v35
  v_exp_f32 v36, v36
  v_exp_f32 v37, v37
  s_waitcnt lgkmcnt(2)
  v_mfma_f32_32x32x16_bf16 v[48:63], v[92:95], v[112:115], 0
  s_setprio 1
  v_exp_f32 v38, v38
  v_exp_f32 v39, v39
  v_exp_f32 v40, v40
  v_exp_f32 v41, v41
  v_exp_f32 v42, v42
  v_smfmac_f32_32x32x32_bf16 v[72:87], v[96:99], v[32:39], v64
  v_exp_f32 v43, v43
  v_exp_f32 v44, v44
  v_exp_f32 v45, v45
  v_exp_f32 v46, v46
  v_exp_f32 v47, v47
  v_exp_f32 v48, v48
  v_exp_f32 v49, v49
  v_smfmac_f32_32x32x32_bf16 v[72:87], v[100:103], v[40:47], v64
  v_exp_f32 v50, v50
  v_exp_f32 v51, v51
  v_exp_f32 v52, v52
  v_exp_f32 v53, v53
  v_exp_f32 v54, v54
  v_exp_f32 v55, v55
  v_exp_f32 v56, v56
  v_exp_f32 v57, v57
  v_exp_f32 v58, v58
  s_waitcnt lgkmcnt(0)
  v_smfmac_f32_32x32x32_bf16 v[72:87], v[104:107], v[48:55], v64
  s_setprio 0
  v_exp_f32 v59, v59
  v_exp_f32 v60, v60
  v_exp_f32 v61, v61
  v_exp_f32 v62, v62
  v_exp_f32 v63, v63
  s_nop 1
  v_smfmac_f32_32x32x32_bf16 v[72:87], v[108:111], v[56:63], v64
  s_add_u32 s54, s51, s4
  s_lshl_b32 s54, s54, 15
  s_lshl_b32 s55, s48, 2
  s_add_u32 s55, s55, s5
  s_lshl_b32 s55, s55, 10
  s_add_u32 s55, s55, s54
  s_add_u32 s56, s55, 2097152
  s_mov_b32 s57, 0x21800000
  s_mov_b32 s58, 0x7b800000
  s_nop 2
  v_add_f32 v80, v80, v84
  v_cmp_nle_f32 vcc, s57, v80
  v_maximum3_f32 v33, abs(v72), abs(v73), v80
  v_maximum3_f32 v34, abs(v74), abs(v75), abs(v76)
  v_maximum3_f32 v33, abs(v77), abs(v78), v33
  v_maximum3_f32 v33, abs(v79), v34, v33
  v_cmp_nge_f32 s[68:69], s58, v33
  s_nop 0
  s_or_b64 vcc, vcc, s[68:69]
  s_cbranch_scc1 L_fb
L_fb_done:
  v_rcp_f32 v32, v80
  s_nop 0
  v_mul_f32 v72, v72, v32
  v_mul_f32 v73, v73, v32
  v_mul_f32 v74, v74, v32
  v_mul_f32 v75, v75, v32
  v_mul_f32 v76, v76, v32
  v_mul_f32 v77, v77, v32
  v_mul_f32 v78, v78, v32
  v_mul_f32 v79, v79, v32
  v_cvt_pk_bf16_f32 v36, v72, v73
  v_cvt_pk_bf16_f32 v37, v74, v75
  v_cvt_pk_bf16_f32 v38, v76, v77
  v_cvt_pk_bf16_f32 v39, v78, v79
  s_cmp_eq_u32 s64, 0
  s_cbranch_scc1 L_sl_12
  buffer_store_dwordx4 v[36:39], v1, s[40:43], s56 offen
L_sj_13:
  s_and_b32 s96, s44, 3
  s_lshr_b32 s97, s44, 2
  s_lshr_b32 s55, s96, 1
  s_add_u32 s54, s51, s55
  s_lshl_b32 s54, s54, 15
  s_and_b32 s57, s53, 0xf8
  s_lshl_b32 s56, s97, 2
  s_add_u32 s57, s57, s56
  s_lshl_b32 s57, s57, 7
  s_lshl_b32 s55, s55, 2
  s_add_u32 s57, s57, s55
  s_add_u32 s57, s57, 65536
  v_bfe_u32 v125, v0, 2, 2
  v_lshlrev_b32 v125, 7, v125
  v_and_b32 v43, 3, v0
  v_lshl_add_u32 v125, v43, 3, v125
  s_lshl_b32 s55, s97, 15
  v_add_u32 v6, s55, v2
  v_lshrrev_b32 v5, 5, v0
  v_lshlrev_b32 v3, 10, v5
  v_sub_u32 v3, v2, v3
  s_and_b32 s55, s96, 1
  s_lshl_b32 s55, s55, 8
  s_add_u32 s55, s55, s54
  s_lshl_b32 s56, s97, 14
  s_add_u32 s56, s56, s55
  s_add_u32 s56, s56, 2097152
  s_waitcnt vmcnt(0)
  v_mov_b32 v32, s49
  s_add_u32 s59, s67, 0
  s_mov_b64 exec, 1
  s_cmp_eq_u32 s64, 0
  s_cbranch_scc1 L_sl_14
  buffer_store_dword v32, off, s[40:43], s59
L_sj_15:
  s_mov_b64 exec, -1
  s_barrier
  ds_read_b128 v[80:83], v6 offset:0
  ds_read_b128 v[84:87], v6 offset:256
  ds_read_b128 v[88:91], v6 offset:1024
  ds_read_b128 v[92:95], v6 offset:1280
  ds_read_b128 v[96:99], v6 offset:4096
  ds_read_b128 v[100:103], v6 offset:4352
  ds_read_b128 v[104:107], v6 offset:5120
  ds_read_b128 v[108:111], v6 offset:5376
  ds_read_b128 v[112:115], v6 offset:8192
  ds_read_b128 v[28:31], v6 offset:8448
  ds_read_b128 v[116:119], v6 offset:9216
  ds_read_b128 v[120:123], v6 offset:9472
  s_mov_b32 s58, 0x80000
L_pl_17:
  buffer_load_dword v126, v125, s[40:43], s57 offen sc1
  s_waitcnt vmcnt(0)
  s_sub_u32 s58, s58, 1
  s_cmp_eq_u32 s58, 0
  s_cbranch_scc1 L_pd_18
  v_cmp_ne_u32 vcc, s49, v126
  s_cbranch_vccnz L_pl_17
L_pd_18:
L_ep_16:
  buffer_load_dwordx4 v[32:35], v3, s[40:43], s56 offen offset:0 sc1
  buffer_load_dwordx4 v[36:39], v3, s[40:43], s56 offen offset:2048 sc1
  s_add_u32 s56, s56, 4096
  buffer_load_dwordx4 v[40:43], v3, s[40:43], s56 offen offset:0 sc1
  buffer_load_dwordx4 v[44:47], v3, s[40:43], s56 offen offset:2048 sc1
  s_add_u32 s56, s56, 4096
  buffer_load_dwordx4 v[48:51], v3, s[40:43], s56 offen offset:0 sc1
  buffer_load_dwordx4 v[52:55], v3, s[40:43], s56 offen offset:2048 sc1
  s_add_u32 s56, s56, 4096
  buffer_load_dwordx4 v[56:59], v3, s[40:43], s56 offen offset:0 sc1
  buffer_load_dwordx4 v[60:63], v3, s[40:43], s56 offen offset:2048 sc1
  v_and_b32 v126, 15, v0
  v_lshlrev_b32 v126, 3, v126
  s_lshl_b32 s57, s48, 1
  s_add_u32 s57, s57, s97
  s_lshl_b32 s57, s57, 11
  s_add_u32 s55, s55, s57
  s_add_u32 s55, s55, 4194304
  s_lshl_b32 s57, s44, 11
  s_add_u32 s57, s57, 65536
  v_add_u32 v124, s57, v1
  v_xor_b32 v125, 0x2000, v124
  s_cmp_eq_u32 s97, 0
  s_waitcnt vmcnt(7) lgkmcnt(8)
  v_mfma_f32_16x16x32_bf16 v[64:67], v[80:83], v[32:35], 0
  v_mfma_f32_16x16x32_bf16 v[68:71], v[84:87], v[32:35], 0
  v_mfma_f32_16x16x32_bf16 v[72:75], v[88:91], v[32:35], 0
  v_mfma_f32_16x16x32_bf16 v[76:79], v[92:95], v[32:35], 0
  ds_read_b128 v[80:83], v6 offset:12288
  ds_read_b128 v[84:87], v6 offset:12544
  ds_read_b128 v[88:91], v6 offset:13312
  ds_read_b128 v[92:95], v6 offset:13568
  s_waitcnt vmcnt(6) lgkmcnt(8)
  v_mfma_f32_16x16x32_bf16 v[64:67], v[96:99], v[36:39], v[64:67]
  v_mfma_f32_16x16x32_bf16 v[68:71], v[100:103], v[36:39], v[68:71]
  v_mfma_f32_16x16x32_bf16 v[72:75], v[104:107], v[36:39], v[72:75]
  v_mfma_f32_16x16x32_bf16 v[76:79], v[108:111], v[36:39], v[76:79]
  ds_read_b128 v[96:99], v6 offset:16384
  ds_read_b128 v[100:103], v6 offset:16640
  ds_read_b128 v[104:107], v6 offset:17408
  ds_read_b128 v[108:111], v6 offset:17664
  s_waitcnt vmcnt(5) lgkmcnt(8)
  v_mfma_f32_16x16x32_bf16 v[64:67], v[112:115], v[40:43], v[64:67]
  v_mfma_f32_16x16x32_bf16 v[68:71], v[28:31], v[40:43], v[68:71]
  v_mfma_f32_16x16x32_bf16 v[72:75], v[116:119], v[40:43], v[72:75]
  v_mfma_f32_16x16x32_bf16 v[76:79], v[120:123], v[40:43], v[76:79]
  ds_read_b128 v[112:115], v6 offset:20480
  ds_read_b128 v[28:31], v6 offset:20736
  ds_read_b128 v[116:119], v6 offset:21504
  ds_read_b128 v[120:123], v6 offset:21760
  s_waitcnt vmcnt(4) lgkmcnt(8)
  v_mfma_f32_16x16x32_bf16 v[64:67], v[80:83], v[44:47], v[64:67]
  v_mfma_f32_16x16x32_bf16 v[68:71], v[84:87], v[44:47], v[68:71]
  v_mfma_f32_16x16x32_bf16 v[72:75], v[88:91], v[44:47], v[72:75]
  v_mfma_f32_16x16x32_bf16 v[76:79], v[92:95], v[44:47], v[76:79]
  ds_read_b128 v[80:83], v6 offset:24576
  ds_read_b128 v[84:87], v6 offset:24832
  ds_read_b128 v[88:91], v6 offset:25600
  ds_read_b128 v[92:95], v6 offset:25856
  s_waitcnt vmcnt(3) lgkmcnt(8)
  v_mfma_f32_16x16x32_bf16 v[64:67], v[96:99], v[48:51], v[64:67]
  v_mfma_f32_16x16x32_bf16 v[68:71], v[100:103], v[48:51], v[68:71]
  v_mfma_f32_16x16x32_bf16 v[72:75], v[104:107], v[48:51], v[72:75]
  v_mfma_f32_16x16x32_bf16 v[76:79], v[108:111], v[48:51], v[76:79]
  ds_read_b128 v[96:99], v6 offset:28672
  ds_read_b128 v[100:103], v6 offset:28928
  ds_read_b128 v[104:107], v6 offset:29696
  ds_read_b128 v[108:111], v6 offset:29952
  s_waitcnt vmcnt(2) lgkmcnt(8)
  v_mfma_f32_16x16x32_bf16 v[64:67], v[112:115], v[52:55], v[64:67]
  v_mfma_f32_16x16x32_bf16 v[68:71], v[28:31], v[52:55], v[68:71]
  v_mfma_f32_16x16x32_bf16 v[72:75], v[116:119], v[52:55], v[72:75]
  v_mfma_f32_16x16x32_bf16 v[76:79], v[120:123], v[52:55], v[76:79]
  s_waitcnt vmcnt(1) lgkmcnt(4)
  v_mfma_f32_16x16x32_bf16 v[64:67], v[80:83], v[56:59], v[64:67]
  v_mfma_f32_16x16x32_bf16 v[68:71], v[84:87], v[56:59], v[68:71]
  v_mfma_f32_16x16x32_bf16 v[72:75], v[88:91], v[56:59], v[72:75]
  v_mfma_f32_16x16x32_bf16 v[76:79], v[92:95], v[56:59], v[76:79]
  s_waitcnt vmcnt(0) lgkmcnt(0)
  v_mfma_f32_16x16x32_bf16 v[64:67], v[96:99], v[60:63], v[64:67]
  v_mfma_f32_16x16x32_bf16 v[68:71], v[100:103], v[60:63], v[68:71]
  v_mfma_f32_16x16x32_bf16 v[72:75], v[104:107], v[60:63], v[72:75]
  v_mfma_f32_16x16x32_bf16 v[76:79], v[108:111], v[60:63], v[76:79]
  v_lshlrev_b32 v32, 16, v24
  v_and_b32 v33, s61, v24
  v_lshlrev_b32 v34, 16, v25
  v_and_b32 v35, s61, v25
  v_lshlrev_b32 v36, 16, v26
  v_and_b32 v37, s61, v26
  v_lshlrev_b32 v38, 16, v27
  v_and_b32 v39, s61, v27
  s_cbranch_scc0 L_p3_hi
  ds_write_b128 v124, v[72:75]
  ds_write_b128 v124, v[76:79] offset:1024
  v_add_f32 v32, v32, v64
  v_add_f32 v33, v33, v65
  v_add_f32 v34, v34, v66
  v_add_f32 v35, v35, v67
  v_add_f32 v36, v36, v68
  v_add_f32 v37, v37, v69
  v_add_f32 v38, v38, v70
  v_add_f32 v39, v39, v71
  s_branch L_p3_j
L_p3_hi:
  ds_write_b128 v124, v[64:67]
  ds_write_b128 v124, v[68:71] offset:1024
  v_add_f32 v32, v32, v72
  v_add_f32 v33, v33, v73
  v_add_f32 v34, v34, v74
  v_add_f32 v35, v35, v75
  v_add_f32 v36, v36, v76
  v_add_f32 v37, v37, v77
  v_add_f32 v38, v38, v78
  v_add_f32 v39, v39, v79
L_p3_j:
  v_add_u32 v4, s83, v2
  v_add_u32 v2, s63, v2
  v_add_u32 v6, 0x10000, v4
  s_sub_u32 s98, s66, s83
  v_mov_b32 v76, 0
  v_mov_b32 v77, 0
  v_mov_b32 v78, s60
  s_waitcnt lgkmcnt(0)
  s_barrier
  ds_read_b128 v[40:43], v125
  ds_read_b128 v[44:47], v125 offset:1024
  s_waitcnt lgkmcnt(0)
  v_add_f32 v32, v32, v40
  v_add_f32 v33, v33, v41
  v_add_f32 v34, v34, v42
  v_add_f32 v35, v35, v43
  v_add_f32 v36, v36, v44
  v_add_f32 v37, v37, v45
  v_add_f32 v38, v38, v46
  v_add_f32 v39, v39, v47
  v_cvt_pk_bf16_f32 v72, v32, v33
  v_cvt_pk_bf16_f32 v73, v34, v35
  v_cvt_pk_bf16_f32 v74, v36, v37
  v_cvt_pk_bf16_f32 v75, v38, v39
  s_nop 0
  v_permlane32_swap_b32 v72, v74
  v_permlane32_swap_b32 v73, v75
  s_cmp_eq_u32 s64, 0
  s_cbranch_scc1 L_sl_19
  buffer_store_dwordx4 v[72:75], v3, s[40:43], s55 offen
L_sj_20:
  v_dot2c_f32_bf16 v76, v72, v78
  v_dot2c_f32_bf16 v77, v72, v72
  v_dot2c_f32_bf16 v76, v73, v78
  v_dot2c_f32_bf16 v77, v73, v73
  v_dot2c_f32_bf16 v76, v74, v78
  v_dot2c_f32_bf16 v77, v74, v74
  v_dot2c_f32_bf16 v76, v75, v78
  v_dot2c_f32_bf16 v77, v75, v75
  s_nop 1
  v_mov_b32 v78, v76
  v_mov_b32 v79, v77
  s_nop 0
  v_permlane16_swap_b32 v76, v78
  v_permlane16_swap_b32 v77, v79
  v_add_f32 v76, v76, v78
  v_add_f32 v77, v77, v79
  v_mov_b32 v78, v76
  v_mov_b32 v79, v77
  s_nop 0
  v_permlane32_swap_b32 v76, v78
  v_permlane32_swap_b32 v77, v79
  v_add_f32 v76, v76, v78
  v_add_f32 v77, v77, v79
  s_mov_b64 exec, 0xffff
  s_cmp_eq_u32 s64, 0
  s_cbranch_scc1 L_sl_21
  buffer_store_dwordx2 v[76:77], v126, s[40:43], s62 offen
L_sj_22:
  s_mov_b64 exec, -1
  v_lshrrev_b32 v41, 4, v0
  v_bfe_u32 v42, v0, 3, 1
  v_lshrrev_b32 v43, 2, v0
  v_xor_b32 v43, v41, v43
  v_and_b32 v43, 1, v43
  v_cmp_eq_u32 vcc, 0, v43
  v_mov_b32 v43, s60
  s_lshl_b32 s72, s45, 17
  v_cndmask_b32 v52, 0, v43, vcc
  v_mov_b32 v53, v52
  v_mov_b32 v54, v52
  v_mov_b32 v55, v52
  s_add_u32 s72, s72, s83
  s_add_u32 s72, s72, 4194304
  s_lshl_b32 s54, s45, 4
  s_add_u32 s54, s54, s44
  s_lshl_b32 s54, s54, 7
  s_add_u32 s54, s54, 98304
  v_lshlrev_b32 v80, 10, v42
  v_and_b32 v81, 7, v0
  v_lshl_add_u32 v80, v81, 2, v80
  v_mfma_f32_16x16x32_bf16 v[48:51], v[52:55], a[0:3], 0
  v_mfma_f32_16x16x32_bf16 v[48:51], v[52:55], a[4:7], v[48:51]
  v_mfma_f32_16x16x32_bf16 v[48:51], v[52:55], a[8:11], v[48:51]
  v_mfma_f32_16x16x32_bf16 v[48:51], v[52:55], a[12:15], v[48:51]
  v_mfma_f32_16x16x32_bf16 v[48:51], v[52:55], a[16:19], v[48:51]
  v_mfma_f32_16x16x32_bf16 v[48:51], v[52:55], a[20:23], v[48:51]
  s_waitcnt vmcnt(0)
  v_mov_b32 v82, s49
  s_add_u32 s59, s67, 32768
  s_mov_b64 exec, 1
  s_cmp_eq_u32 s64, 0
  s_cbranch_scc1 L_sl_23
  buffer_store_dword v82, off, s[40:43], s59
L_sj_24:
  s_mov_b64 exec, -1
  v_mfma_f32_16x16x32_bf16 v[48:51], v[52:55], a[24:27], v[48:51]
  v_mfma_f32_16x16x32_bf16 v[48:51], v[52:55], a[28:31], v[48:51]
  v_mfma_f32_16x16x32_bf16 v[48:51], v[52:55], a[32:35], v[48:51]
  v_mfma_f32_16x16x32_bf16 v[48:51], v[52:55], a[36:39], v[48:51]
  v_mfma_f32_16x16x32_bf16 v[48:51], v[52:55], a[40:43], v[48:51]
  v_mfma_f32_16x16x32_bf16 v[48:51], v[52:55], a[44:47], v[48:51]
  v_mfma_f32_16x16x32_bf16 v[48:51], v[52:55], a[48:51], v[48:51]
  v_mfma_f32_16x16x32_bf16 v[48:51], v[52:55], a[52:55], v[48:51]
  s_mov_b32 s58, 0x80000
L_pl_26:
  buffer_load_dword v81, v80, s[40:43], s54 offen sc1
  s_waitcnt vmcnt(0)
  s_sub_u32 s58, s58, 1
  s_cmp_eq_u32 s58, 0
  s_cbranch_scc1 L_pd_27
  v_cmp_ne_u32 vcc, s49, v81
  s_cbranch_vccnz L_pl_26
L_pd_27:
L_ep_25:
  s_waitcnt lgkmcnt(0)
  s_add_u32 m0, s83, 0
  s_add_u32 s55, s72, 0
  buffer_load_dwordx4 v1, s[40:43], s55 offen offset:0 sc1 lds
  v_mfma_f32_16x16x32_bf16 v[48:51], v[52:55], a[56:59], v[48:51]
  buffer_load_dwordx4 v1, s[40:43], s55 offen offset:1024 sc1 lds
  v_mfma_f32_16x16x32_bf16 v[48:51], v[52:55], a[60:63], v[48:51]
  buffer_load_dwordx4 v1, s[40:43], s55 offen offset:2048 sc1 lds
  v_mfma_f32_16x16x32_bf16 v[48:51], v[52:55], a[64:67], v[48:51]
  buffer_load_dwordx4 v1, s[40:43], s55 offen offset:3072 sc1 lds
  v_mfma_f32_16x16x32_bf16 v[48:51], v[52:55], a[68:71], v[48:51]
  v_mfma_f32_16x16x32_bf16 v[48:51], v[52:55], a[72:75], v[48:51]
  v_mfma_f32_16x16x32_bf16 v[48:51], v[52:55], a[76:79], v[48:51]
  v_mfma_f32_16x16x32_bf16 v[48:51], v[52:55], a[80:83], v[48:51]
  v_mfma_f32_16x16x32_bf16 v[48:51], v[52:55], a[84:87], v[48:51]
  v_mfma_f32_16x16x32_bf16 v[48:51], v[52:55], a[88:91], v[48:51]
  v_mfma_f32_16x16x32_bf16 v[48:51], v[52:55], a[92:95], v[48:51]
  v_mfma_f32_16x16x32_bf16 v[48:51], v[52:55], a[96:99], v[48:51]
  v_mfma_f32_16x16x32_bf16 v[48:51], v[52:55], a[100:103], v[48:51]
  v_mfma_f32_16x16x32_bf16 v[48:51], v[52:55], a[104:107], v[48:51]
  v_mfma_f32_16x16x32_bf16 v[48:51], v[52:55], a[108:111], v[48:51]
  v_mfma_f32_16x16x32_bf16 v[48:51], v[52:55], a[112:115], v[48:51]
  v_mfma_f32_16x16x32_bf16 v[48:51], v[52:55], a[116:119], v[48:51]
  v_mfma_f32_16x16x32_bf16 v[48:51], v[52:55], a[120:123], v[48:51]
  v_mfma_f32_16x16x32_bf16 v[48:51], v[52:55], a[124:127], v[48:51]
  v_add_u32 v5, 0x10000, v1
  v_cmp_gt_u32 vcc, 32, v0
  v_mov_b32 v94, 0
  v_mov_b32 v95, 0
  s_and_b32 s56, s44, 3
  s_lshl_b32 s56, s56, 2
  s_lshl_b32 s57, s47, 4
  s_add_u32 s99, s56, s57
  v_add_u32 v82, s99, v41
  v_cndmask_b32 v48, 0, v48, vcc
  v_cvt_pk_bf16_f32 v93, v48, 0
  v_lshlrev_b32 v49, 16, v93
  v_sub_f32 v49, v48, v49
  v_cvt_pk_bf16_f32 v92, v49, 0
  v_lshl_or_b32 v92, v92, 16, v93
  v_and_b32 v83, 1, v0
  v_lshl_add_u32 v83, v83, 5, v82
  v_lshlrev_b32 v83, 4, v83
  v_bfe_u32 v84, v0, 1, 1
  v_lshl_add_u32 v83, v84, 3, v83
  v_bfe_u32 v84, v0, 2, 2
  v_lshl_add_u32 v114, v84, 10, v83
  s_lshl_b32 s57, s47, 8
  v_add_u32 v126, s57, v3
  s_lshl_b32 s100, s45, 2
  s_lshr_b32 s56, s44, 2
  s_add_u32 s100, s100, s56
  s_lshl_b32 s100, s100, 15
  s_lshl_b32 s56, s48, 12
  s_add_u32 s74, s100, s56
  s_add_u32 s74, s74, 4194304
  s_mul_i32 s75, s45, 458752
  s_mul_i32 s56, s44, 14336
  s_add_u32 s75, s75, s56
  s_add_u32 s75, s75, 6291456
  s_lshl_b32 s96, s45, 17
  s_add_u32 s96, s96, 2097152
  s_add_u32 s97, s56, s96
  s_mul_i32 s56, s46, 7
  s_add_u32 s56, s56, s44
  s_lshl_b32 s56, s56, 10
  s_add_u32 s96, s96, s56
  s_lshl_b32 s56, s45, 4
  s_lshl_b32 s57, s44, 1
  s_add_u32 s56, s56, s57
  s_lshl_b32 s76, s56, 7
  s_add_u32 s76, s76, 131072
  v_and_b32 v0, 31, v0
  v_lshlrev_b32 v0, 4, v0
  v_add_u32 v0, 131072, v0
  v_and_b32 v3, 0xf0, v1
  v_lshrrev_b32 v3, 2, v3
  v_and_b32 v125, 28, v3
  v_min_u32 v125, 24, v125
  v_lshrrev_b32 v3, 5, v3
  v_lshl_add_u32 v3, v3, 7, v125
  s_add_u32 m0, s83, 32768
  s_add_u32 s55, s72, 32768
  buffer_load_dwordx4 v1, s[40:43], s55 offen offset:0 sc1 lds
  buffer_load_dwordx4 v1, s[40:43], s55 offen offset:1024 sc1 lds
  buffer_load_dwordx4 v1, s[40:43], s55 offen offset:2048 sc1 lds
  buffer_load_dwordx4 v1, s[40:43], s55 offen offset:3072 sc1 lds
  s_waitcnt vmcnt(4) lgkmcnt(0)
  s_barrier
  s_cmp_eq_u32 s44, 7
  s_cbranch_scc1 L_gu_w7
  ds_read_b128 v[64:67], v1 offset:0
  ds_read_b128 v[68:71], v1 offset:1024
  ds_read_b128 v[72:75], v1 offset:2048
  ds_read_b128 v[76:79], v1 offset:3072
  s_waitcnt lgkmcnt(3)
  v_mfma_f32_32x32x16_bf16 v[32:47], a[0:3], v[64:67], 0
  ds_read_b128 v[64:67], v1 offset:4096
  s_waitcnt lgkmcnt(3)
  v_mfma_f32_32x32x16_bf16 v[32:47], a[4:7], v[68:71], v[32:47]
  ds_read_b128 v[68:71], v1 offset:5120
  s_waitcnt lgkmcnt(3)
  v_mfma_f32_32x32x16_bf16 v[32:47], a[8:11], v[72:75], v[32:47]
  s_add_u32 m0, s83, 65536
  s_add_u32 s55, s72, 65536
  buffer_load_dwordx4 v1, s[40:43], s55 offen offset:0 sc1 lds
  ds_read_b128 v[72:75], v1 offset:6144
  s_waitcnt lgkmcnt(3)
  v_mfma_f32_32x32x16_bf16 v[32:47], a[12:15], v[76:79], v[32:47]
  ds_read_b128 v[76:79], v1 offset:7168
  s_waitcnt lgkmcnt(3)
  v_mfma_f32_32x32x16_bf16 v[32:47], a[16:19], v[64:67], v[32:47]
  ds_read_b128 v[64:67], v1 offset:8192
  s_waitcnt lgkmcnt(3)
  v_mfma_f32_32x32x16_bf16 v[32:47], a[20:23], v[68:71], v[32:47]
  s_add_u32 m0, s83, 65536
  s_add_u32 s55, s72, 65536
  buffer_load_dwordx4 v1, s[40:43], s55 offen offset:1024 sc1 lds
  ds_read_b128 v[68:71], v1 offset:9216
  s_waitcnt lgkmcnt(3)
  v_mfma_f32_32x32x16_bf16 v[32:47], a[24:27], v[72:75], v[32:47]
  ds_read_b128 v[72:75], v1 offset:10240
  s_waitcnt lgkmcnt(3)
  v_mfma_f32_32x32x16_bf16 v[32:47], a[28:31], v[76:79], v[32:47]
  ds_read_b128 v[76:79], v1 offset:11264
  s_waitcnt lgkmcnt(3)
  v_mfma_f32_32x32x16_bf16 v[32:47], a[32:35], v[64:67], v[32:47]
  s_add_u32 m0, s83, 65536
  s_add_u32 s55, s72, 65536
  buffer_load_dwordx4 v1, s[40:43], s55 offen offset:2048 sc1 lds
  ds_read_b128 v[64:67], v1 offset:12288
  s_waitcnt lgkmcnt(3)
  v_mfma_f32_32x32x16_bf16 v[32:47], a[36:39], v[68:71], v[32:47]
  ds_read_b128 v[68:71], v1 offset:13312
  s_waitcnt lgkmcnt(3)
  v_mfma_f32_32x32x16_bf16 v[32:47], a[40:43], v[72:75], v[32:47]
  ds_read_b128 v[72:75], v1 offset:14336
  s_waitcnt lgkmcnt(3)
  v_mfma_f32_32x32x16_bf16 v[32:47], a[44:47], v[76:79], v[32:47]
  s_add_u32 m0, s83, 65536
  s_add_u32 s55, s72, 65536
  buffer_load_dwordx4 v1, s[40:43], s55 offen offset:3072 sc1 lds
  ds_read_b128 v[76:79], v1 offset:15360
  s_waitcnt lgkmcnt(3)
  v_mfma_f32_32x32x16_bf16 v[32:47], a[48:51], v[64:67], v[32:47]
  ds_read_b128 v[64:67], v1 offset:16384
  s_waitcnt lgkmcnt(3)
  v_mfma_f32_32x32x16_bf16 v[32:47], a[52:55], v[68:71], v[32:47]
  ds_read_b128 v[68:71], v1 offset:17408
  s_waitcnt lgkmcnt(3)
  v_mfma_f32_32x32x16_bf16 v[32:47], a[56:59], v[72:75], v[32:47]
  s_add_u32 m0, s83, 98304
  s_add_u32 s55, s72, 98304
  buffer_load_dwordx4 v1, s[40:43], s55 offen offset:0 sc1 lds
  ds_read_b128 v[72:75], v1 offset:18432
  s_waitcnt lgkmcnt(3)
  v_mfma_f32_32x32x16_bf16 v[32:47], a[60:63], v[76:79], v[32:47]
  ds_read_b128 v[76:79], v1 offset:19456
  s_waitcnt lgkmcnt(3)
  v_mfma_f32_32x32x16_bf16 v[32:47], a[64:67], v[64:67], v[32:47]
  ds_read_b128 v[64:67], v1 offset:20480
  s_waitcnt lgkmcnt(3)
  v_mfma_f32_32x32x16_bf16 v[32:47], a[68:71], v[68:71], v[32:47]
  s_add_u32 m0, s83, 98304
  s_add_u32 s55, s72, 98304
  buffer_load_dwordx4 v1, s[40:43], s55 offen offset:1024 sc1 lds
  ds_read_b128 v[68:71], v1 offset:21504
  s_waitcnt lgkmcnt(3)
  v_mfma_f32_32x32x16_bf16 v[32:47], a[72:75], v[72:75], v[32:47]
  ds_read_b128 v[72:75], v1 offset:22528
  s_waitcnt lgkmcnt(3)
  v_mfma_f32_32x32x16_bf16 v[32:47], a[76:79], v[76:79], v[32:47]
  ds_read_b128 v[76:79], v1 offset:23552
  s_waitcnt lgkmcnt(3)
  v_mfma_f32_32x32x16_bf16 v[32:47], a[80:83], v[64:67], v[32:47]
  s_add_u32 m0, s83, 98304
  s_add_u32 s55, s72, 98304
  buffer_load_dwordx4 v1, s[40:43], s55 offen offset:2048 sc1 lds
  ds_read_b128 v[64:67], v1 offset:24576
  s_waitcnt lgkmcnt(3)
  v_mfma_f32_32x32x16_bf16 v[32:47], a[84:87], v[68:71], v[32:47]
  ds_read_b128 v[68:71], v1 offset:25600
  s_waitcnt lgkmcnt(3)
  v_mfma_f32_32x32x16_bf16 v[32:47], a[88:91], v[72:75], v[32:47]
  ds_read_b128 v[72:75], v1 offset:26624
  s_waitcnt lgkmcnt(3)
  v_mfma_f32_32x32x16_bf16 v[32:47], a[92:95], v[76:79], v[32:47]
  s_add_u32 m0, s83, 98304
  s_add_u32 s55, s72, 98304
  buffer_load_dwordx4 v1, s[40:43], s55 offen offset:3072 sc1 lds
  ds_read_b128 v[76:79], v1 offset:27648
  s_waitcnt lgkmcnt(3)
  v_mfma_f32_32x32x16_bf16 v[32:47], a[96:99], v[64:67], v[32:47]
  ds_read_b128 v[64:67], v1 offset:28672
  s_waitcnt lgkmcnt(3)
  v_mfma_f32_32x32x16_bf16 v[32:47], a[100:103], v[68:71], v[32:47]
  ds_read_b128 v[68:71], v1 offset:29696
  s_waitcnt lgkmcnt(3)
  v_mfma_f32_32x32x16_bf16 v[32:47], a[104:107], v[72:75], v[32:47]
  s_waitcnt vmcnt(8)
  s_barrier
  ds_read_b128 v[72:75], v1 offset:30720
  s_waitcnt lgkmcnt(3)
  v_mfma_f32_32x32x16_bf16 v[32:47], a[108:111], v[76:79], v[32:47]
  ds_read_b128 v[76:79], v1 offset:31744
  s_waitcnt lgkmcnt(3)
  v_mfma_f32_32x32x16_bf16 v[32:47], a[112:115], v[64:67], v[32:47]
  s_add_u32 s57, s74, 65536
  buffer_load_dwordx2 v[112:113], v114, s[40:43], s74 offen sc1
  buffer_load_dwordx2 v[114:115], v114, s[40:43], s57 offen sc1
  ds_read_b128 v[84:87], v0 offset:30720
  ds_read_b128 v[64:67], v1 offset:32768
  s_waitcnt lgkmcnt(4)
  v_mfma_f32_32x32x16_bf16 v[32:47], a[116:119], v[68:71], v[32:47]
  ds_read_b128 v[68:71], v1 offset:33792
  s_waitcnt lgkmcnt(4)
  v_mfma_f32_32x32x16_bf16 v[32:47], a[120:123], v[72:75], v[32:47]
  s_waitcnt lgkmcnt(2)
  v_mfma_f32_32x32x16_bf16 v[32:47], v[92:95], v[84:87], v[32:47]
  ds_read_b128 v[72:75], v1 offset:34816
  v_mfma_f32_32x32x16_bf16 v[32:47], a[124:127], v[76:79], v[32:47]
  ds_read_b64 v[124:125], v0 offset:8
  ds_read_b32 v88, v0 offset:4
  ds_read_b128 v[76:79], v1 offset:35840
  s_waitcnt lgkmcnt(5)
  v_mfma_f32_32x32x16_bf16 v[48:63], a[0:3], v[64:67], 0
  s_add_u32 s55, s98, 20480
  buffer_load_dwordx4 v[24:27], v4, s[40:43], s55 offen offset:0 sc1
  ds_read_b128 v[64:67], v1 offset:36864
  s_waitcnt lgkmcnt(5)
  v_mfma_f32_32x32x16_bf16 v[48:63], a[4:7], v[68:71], v[48:63]
  ds_read_b128 v[68:71], v1 offset:37888
  s_waitcnt lgkmcnt(5)
  v_mfma_f32_32x32x16_bf16 v[48:63], a[8:11], v[72:75], v[48:63]
  s_add_u32 s55, s98, 20480
  buffer_load_dwordx4 v[28:31], v4, s[40:43], s55 offen offset:256 sc1
  ds_read_b128 v[72:75], v1 offset:38912
  s_waitcnt lgkmcnt(3)
  v_mfma_f32_32x32x16_bf16 v[48:63], a[12:15], v[76:79], v[48:63]
  v_mul_f32 v80, v32, v32
  v_mul_f32 v81, v33, v33
  v_mul_f32 v82, v34, v34
  v_mul_f32 v83, v35, v35
  ds_read_b128 v[76:79], v1 offset:39936
  s_waitcnt lgkmcnt(3)
  v_mfma_f32_32x32x16_bf16 v[48:63], a[16:19], v[64:67], v[48:63]
  s_add_u32 s55, s98, 20480
  buffer_load_dwordx4 v[96:99], v4, s[40:43], s55 offen offset:1024 sc1
  v_mul_f32 v84, v36, v36
  v_mul_f32 v85, v37, v37
  v_mul_f32 v86, v38, v38
  v_mul_f32 v87, v39, v39
  ds_read_b128 v[64:67], v1 offset:40960
  s_waitcnt lgkmcnt(3)
  v_mfma_f32_32x32x16_bf16 v[48:63], a[20:23], v[68:71], v[48:63]
  v_mul_f32 v40, v32, v40
  v_mul_f32 v41, v33, v41
  v_mul_f32 v42, v34, v42
  v_mul_f32 v43, v35, v43
  ds_read_b128 v[68:71], v1 offset:41984
  s_waitcnt lgkmcnt(3)
  v_mfma_f32_32x32x16_bf16 v[48:63], a[24:27], v[72:75], v[48:63]
  s_add_u32 s55, s98, 20480
  buffer_load_dwordx4 v[100:103], v4, s[40:43], s55 offen offset:1280 sc1
  v_mul_f32 v44, v36, v44
  v_mul_f32 v45, v37, v45
  v_mul_f32 v46, v38, v46
  ds_read_b128 v[72:75], v1 offset:43008
  s_waitcnt lgkmcnt(3)
  v_mfma_f32_32x32x16_bf16 v[48:63], a[28:31], v[76:79], v[48:63]
  v_mul_f32 v47, v39, v47
  v_fma_f32 v80, v80, v125, v124
  v_fma_f32 v81, v81, v125, v124
  ds_read_b128 v[76:79], v1 offset:44032
  s_waitcnt lgkmcnt(3)
  v_mfma_f32_32x32x16_bf16 v[48:63], a[32:35], v[64:67], v[48:63]
  s_add_u32 s55, s98, 24576
  buffer_load_dwordx4 v[116:119], v4, s[40:43], s55 offen offset:0 sc1
  v_fma_f32 v82, v82, v125, v124
  v_fma_f32 v83, v83, v125, v124
  v_fma_f32 v84, v84, v125, v124
  v_fma_f32 v85, v85, v125, v124
  ds_read_b128 v[64:67], v1 offset:45056
  s_waitcnt lgkmcnt(3)
  v_mfma_f32_32x32x16_bf16 v[48:63], a[36:39], v[68:71], v[48:63]
  v_fma_f32 v86, v86, v125, v124
  v_fma_f32 v87, v87, v125, v124
  v_mul_f32 v80, v80, v32
  ds_read_b128 v[68:71], v1 offset:46080
  s_waitcnt lgkmcnt(3)
  v_mfma_f32_32x32x16_bf16 v[48:63], a[40:43], v[72:75], v[48:63]
  s_add_u32 s55, s98, 24576
  buffer_load_dwordx4 v[120:123], v4, s[40:43], s55 offen offset:256 sc1
  v_mul_f32 v81, v81, v33
  v_mul_f32 v82, v82, v34
  v_mul_f32 v83, v83, v35
  v_mul_f32 v84, v84, v36
  ds_read_b128 v[72:75], v1 offset:47104
  s_waitcnt lgkmcnt(3)
  v_mfma_f32_32x32x16_bf16 v[48:63], a[44:47], v[76:79], v[48:63]
  v_mul_f32 v85, v85, v37
  v_mul_f32 v86, v86, v38
  v_mul_f32 v87, v87, v39
  v_exp_f32 v80, v80
  ds_read_b128 v[76:79], v1 offset:48128
  s_waitcnt lgkmcnt(3)
  v_mfma_f32_32x32x16_bf16 v[48:63], a[48:51], v[64:67], v[48:63]
  s_add_u32 s55, s98, 24576
  buffer_load_dwordx4 v[104:107], v4, s[40:43], s55 offen offset:1024 sc1
  v_exp_f32 v81, v81
  v_exp_f32 v82, v82
  v_exp_f32 v83, v83
  ds_read_b128 v[64:67], v1 offset:49152
  s_waitcnt lgkmcnt(3)
  v_mfma_f32_32x32x16_bf16 v[48:63], a[52:55], v[68:71], v[48:63]
  v_exp_f32 v84, v84
  v_exp_f32 v85, v85
  v_exp_f32 v86, v86
  v_exp_f32 v87, v87
  ds_read_b128 v[68:71], v1 offset:50176
  s_waitcnt lgkmcnt(3)
  v_mfma_f32_32x32x16_bf16 v[48:63], a[56:59], v[72:75], v[48:63]
  s_add_u32 s55, s98, 24576
  buffer_load_dwordx4 v[108:111], v4, s[40:43], s55 offen offset:1280 sc1
  v_fma_f32 v80, v80, v88, v88
  v_fma_f32 v81, v81, v88, v88
  v_fma_f32 v82, v82, v88, v88
  v_fma_f32 v83, v83, v88, v88
  ds_read_b128 v[72:75], v1 offset:51200
  s_waitcnt lgkmcnt(3)
  v_mfma_f32_32x32x16_bf16 v[48:63], a[60:63], v[76:79], v[48:63]
  v_fma_f32 v84, v84, v88, v88
  v_fma_f32 v85, v85, v88, v88
  v_fma_f32 v86, v86, v88, v88
  ds_read_b128 v[76:79], v1 offset:52224
  s_waitcnt lgkmcnt(3)
  v_mfma_f32_32x32x16_bf16 v[48:63], a[64:67], v[64:67], v[48:63]
  v_fma_f32 v87, v87, v88, v88
  v_rcp_f32 v80, v80
  v_rcp_f32 v81, v81
  v_rcp_f32 v82, v82
  ds_read_b128 v[64:67], v1 offset:53248
  s_waitcnt lgkmcnt(3)
  v_mfma_f32_32x32x16_bf16 v[48:63], a[68:71], v[68:71], v[48:63]
  v_rcp_f32 v83, v83
  v_rcp_f32 v84, v84
  v_rcp_f32 v85, v85
  v_rcp_f32 v86, v86
  ds_read_b128 v[68:71], v1 offset:54272
  s_waitcnt lgkmcnt(3)
  v_mfma_f32_32x32x16_bf16 v[48:63], a[72:75], v[72:75], v[48:63]
  v_rcp_f32 v87, v87
  v_mul_f32 v32, v40, v80
  v_mul_f32 v33, v41, v81
  ds_read_b128 v[72:75], v1 offset:55296
  s_waitcnt lgkmcnt(3)
  v_mfma_f32_32x32x16_bf16 v[48:63], a[76:79], v[76:79], v[48:63]
  v_mul_f32 v34, v42, v82
  v_mul_f32 v35, v43, v83
  v_mul_f32 v36, v44, v84
  v_mul_f32 v37, v45, v85
  ds_read_b128 v[76:79], v1 offset:56320
  s_waitcnt lgkmcnt(3)
  v_mfma_f32_32x32x16_bf16 v[48:63], a[80:83], v[64:67], v[48:63]
  v_mul_f32 v38, v46, v86
  v_mul_f32 v39, v47, v87
  v_cvt_pk_bf16_f32 v88, v32, v33
  v_cvt_pk_bf16_f32 v89, v34, v35
  ds_read_b128 v[64:67], v1 offset:57344
  s_waitcnt lgkmcnt(3)
  v_mfma_f32_32x32x16_bf16 v[48:63], a[84:87], v[68:71], v[48:63]
  v_cvt_pk_bf16_f32 v90, v36, v37
  v_cvt_pk_bf16_f32 v91, v38, v39
  s_add_u32 s56, s7, 0
  buffer_store_dwordx4 v[88:91], v1, s[40:43], s56 offen sc1
  ds_read_b128 v[68:71], v1 offset:58368
  s_waitcnt lgkmcnt(3)
  v_mfma_f32_32x32x16_bf16 v[48:63], a[88:91], v[72:75], v[48:63]
  ds_read_b128 v[72:75], v1 offset:59392
  s_waitcnt lgkmcnt(3)
  v_mfma_f32_32x32x16_bf16 v[48:63], a[92:95], v[76:79], v[48:63]
  ds_read_b128 v[76:79], v1 offset:60416
  s_waitcnt lgkmcnt(3)
  v_mfma_f32_32x32x16_bf16 v[48:63], a[96:99], v[64:67], v[48:63]
  ds_read_b128 v[64:67], v1 offset:61440
  s_waitcnt lgkmcnt(3)
  v_mfma_f32_32x32x16_bf16 v[48:63], a[100:103], v[68:71], v[48:63]
  ds_read_b128 v[68:71], v1 offset:62464
  s_waitcnt lgkmcnt(3)
  v_mfma_f32_32x32x16_bf16 v[48:63], a[104:107], v[72:75], v[48:63]
  s_waitcnt vmcnt(15)
  s_barrier
  ds_read_b128 v[72:75], v1 offset:63488
  s_waitcnt lgkmcnt(3)
  v_mfma_f32_32x32x16_bf16 v[48:63], a[108:111], v[76:79], v[48:63]
  s_add_u32 m0, s83, 0
  s_add_u32 s57, s66, 4096
  buffer_load_dwordx4 v1, s[40:43], s57 offen offset:0 sc1 lds
  ds_read_b128 v[76:79], v1 offset:64512
  s_waitcnt lgkmcnt(3)
  v_mfma_f32_32x32x16_bf16 v[48:63], a[112:115], v[64:67], v[48:63]
  ds_read_b128 v[84:87], v0 offset:31232
  ds_read_b128 v[64:67], v5 offset:0
  s_waitcnt lgkmcnt(4)
  v_mfma_f32_32x32x16_bf16 v[48:63], a[116:119], v[68:71], v[48:63]
  s_add_u32 m0, s83, 0
  s_add_u32 s57, s66, 4096
  buffer_load_dwordx4 v1, s[40:43], s57 offen offset:1024 sc1 lds
  ds_read_b128 v[68:71], v5 offset:1024
  s_waitcnt lgkmcnt(4)
  v_mfma_f32_32x32x16_bf16 v[48:63], a[120:123], v[72:75], v[48:63]
  s_waitcnt lgkmcnt(2)
  v_mfma_f32_32x32x16_bf16 v[48:63], v[92:95], v[84:87], v[48:63]
  ds_read_b128 v[72:75], v5 offset:2048
  v_mfma_f32_32x32x16_bf16 v[48:63], a[124:127], v[76:79], v[48:63]
  s_add_u32 m0, s83, 2048
  s_add_u32 s57, s66, 6144
  buffer_load_dwordx4 v1, s[40:43], s57 offen offset:0 sc1 lds
  ds_read_b64 v[124:125], v0 offset:520
  ds_read_b32 v88, v0 offset:516
  ds_read_b128 v[76:79], v5 offset:3072
  s_waitcnt lgkmcnt(5)
  v_mfma_f32_32x32x16_bf16 v[32:47], a[0:3], v[64:67], 0
  ds_read_b128 v[64:67], v5 offset:4096
  s_waitcnt lgkmcnt(5)
  v_mfma_f32_32x32x16_bf16 v[32:47], a[4:7], v[68:71], v[32:47]
  s_add_u32 m0, s83, 2048
  s_add_u32 s57, s66, 6144
  buffer_load_dwordx4 v1, s[40:43], s57 offen offset:1024 sc1 lds
  ds_read_b128 v[68:71], v5 offset:5120
  s_waitcnt lgkmcnt(5)
  v_mfma_f32_32x32x16_bf16 v[32:47], a[8:11], v[72:75], v[32:47]
  s_waitcnt vmcnt(15)
  s_barrier
  ds_read_b128 v[72:75], v5 offset:6144
  s_waitcnt lgkmcnt(3)
  v_mfma_f32_32x32x16_bf16 v[32:47], a[12:15], v[76:79], v[32:47]
  v_mul_f32 v80, v48, v48
  v_mul_f32 v81, v49, v49
  v_mul_f32 v82, v50, v50
  v_mul_f32 v83, v51, v51
  ds_read_b128 v[76:79], v5 offset:7168
  s_waitcnt lgkmcnt(3)
  v_mfma_f32_32x32x16_bf16 v[32:47], a[16:19], v[64:67], v[32:47]
  s_add_u32 m0, s83, 32768
  s_add_u32 s57, s66, 8192
  buffer_load_dwordx4 v1, s[40:43], s57 offen offset:0 sc1 lds
  v_mul_f32 v84, v52, v52
  v_mul_f32 v85, v53, v53
  v_mul_f32 v86, v54, v54
  v_mul_f32 v87, v55, v55
  ds_read_b128 v[64:67], v5 offset:8192
  s_waitcnt lgkmcnt(3)
  v_mfma_f32_32x32x16_bf16 v[32:47], a[20:23], v[68:71], v[32:47]
  v_mul_f32 v56, v48, v56
  v_mul_f32 v57, v49, v57
  v_mul_f32 v58, v50, v58
  v_mul_f32 v59, v51, v59
  ds_read_b128 v[68:71], v5 offset:9216
  s_waitcnt lgkmcnt(3)
  v_mfma_f32_32x32x16_bf16 v[32:47], a[24:27], v[72:75], v[32:47]
  v_mul_f32 v60, v52, v60
  v_mul_f32 v61, v53, v61
  v_mul_f32 v62, v54, v62
  ds_read_b128 v[72:75], v5 offset:10240
  s_waitcnt lgkmcnt(3)
  v_mfma_f32_32x32x16_bf16 v[32:47], a[28:31], v[76:79], v[32:47]
  s_add_u32 m0, s83, 32768
  s_add_u32 s57, s66, 8192
  buffer_load_dwordx4 v1, s[40:43], s57 offen offset:1024 sc1 lds
  v_mul_f32 v63, v55, v63
  v_fma_f32 v80, v80, v125, v124
  v_fma_f32 v81, v81, v125, v124
  ds_read_b128 v[76:79], v5 offset:11264
  s_waitcnt lgkmcnt(3)
  v_mfma_f32_32x32x16_bf16 v[32:47], a[32:35], v[64:67], v[32:47]
  v_fma_f32 v82, v82, v125, v124
  v_fma_f32 v83, v83, v125, v124
  v_fma_f32 v84, v84, v125, v124
  v_fma_f32 v85, v85, v125, v124
  s_waitcnt vmcnt(6)
  v_mov_b32 v7, s49
  s_add_u32 s59, s67, 65536
  s_mov_b64 exec, 1
  s_cmp_eq_u32 s64, 0
  s_cbranch_scc1 L_sl_30
  buffer_store_dword v7, off, s[40:43], s59
L_sj_31:
  s_mov_b64 exec, -1
  ds_read_b128 v[64:67], v5 offset:12288
  s_waitcnt lgkmcnt(3)
  v_mfma_f32_32x32x16_bf16 v[32:47], a[36:39], v[68:71], v[32:47]
  v_fma_f32 v86, v86, v125, v124
  v_fma_f32 v87, v87, v125, v124
  v_mul_f32 v80, v80, v48
  ds_read_b128 v[68:71], v5 offset:13312
  s_waitcnt lgkmcnt(3)
  v_mfma_f32_32x32x16_bf16 v[32:47], a[40:43], v[72:75], v[32:47]
  s_add_u32 m0, s83, 34816
  s_add_u32 s57, s66, 10240
  buffer_load_dwordx4 v1, s[40:43], s57 offen offset:0 sc1 lds
  v_mul_f32 v81, v81, v49
  v_mul_f32 v82, v82, v50
  v_mul_f32 v83, v83, v51
  v_mul_f32 v84, v84, v52
  ds_read_b128 v[72:75], v5 offset:14336
  s_waitcnt lgkmcnt(3)
  v_mfma_f32_32x32x16_bf16 v[32:47], a[44:47], v[76:79], v[32:47]
  v_mul_f32 v85, v85, v53
  v_mul_f32 v86, v86, v54
  v_mul_f32 v87, v87, v55
  v_exp_f32 v80, v80
  ds_read_b128 v[76:79], v5 offset:15360
  s_waitcnt lgkmcnt(3)
  v_mfma_f32_32x32x16_bf16 v[32:47], a[48:51], v[64:67], v[32:47]
  v_exp_f32 v81, v81
  v_exp_f32 v82, v82
  v_exp_f32 v83, v83
  ds_read_b128 v[64:67], v5 offset:16384
  s_waitcnt lgkmcnt(3)
  v_mfma_f32_32x32x16_bf16 v[32:47], a[52:55], v[68:71], v[32:47]
  s_add_u32 m0, s83, 34816
  s_add_u32 s57, s66, 10240
  buffer_load_dwordx4 v1, s[40:43], s57 offen offset:1024 sc1 lds
  v_exp_f32 v84, v84
  v_exp_f32 v85, v85
  v_exp_f32 v86, v86
  v_exp_f32 v87, v87
  ds_read_b128 v[68:71], v5 offset:17408
  s_waitcnt lgkmcnt(3)
  v_mfma_f32_32x32x16_bf16 v[32:47], a[56:59], v[72:75], v[32:47]
  v_fma_f32 v80, v80, v88, v88
  v_fma_f32 v81, v81, v88, v88
  v_fma_f32 v82, v82, v88, v88
  v_fma_f32 v83, v83, v88, v88
  ds_read_b128 v[72:75], v5 offset:18432
  s_waitcnt lgkmcnt(3)
  v_mfma_f32_32x32x16_bf16 v[32:47], a[60:63], v[76:79], v[32:47]
  v_fma_f32 v84, v84, v88, v88
  v_fma_f32 v85, v85, v88, v88
  v_fma_f32 v86, v86, v88, v88
  ds_read_b128 v[76:79], v5 offset:19456
  s_waitcnt lgkmcnt(3)
  v_mfma_f32_32x32x16_bf16 v[32:47], a[64:67], v[64:67], v[32:47]
  v_fma_f32 v87, v87, v88, v88
  v_rcp_f32 v80, v80
  v_rcp_f32 v81, v81
  v_rcp_f32 v82, v82
  ds_read_b128 v[64:67], v5 offset:20480
  s_waitcnt lgkmcnt(3)
  v_mfma_f32_32x32x16_bf16 v[32:47], a[68:71], v[68:71], v[32:47]
  v_rcp_f32 v83, v83
  v_rcp_f32 v84, v84
  v_rcp_f32 v85, v85
  v_rcp_f32 v86, v86
  ds_read_b128 v[68:71], v5 offset:21504
  s_waitcnt lgkmcnt(3)
  v_mfma_f32_32x32x16_bf16 v[32:47], a[72:75], v[72:75], v[32:47]
  v_rcp_f32 v87, v87
  v_mul_f32 v48, v56, v80
  v_mul_f32 v49, v57, v81
  ds_read_b128 v[72:75], v5 offset:22528
  s_waitcnt lgkmcnt(3)
  v_mfma_f32_32x32x16_bf16 v[32:47], a[76:79], v[76:79], v[32:47]
  v_mul_f32 v50, v58, v82
  v_mul_f32 v51, v59, v83
  v_mul_f32 v52, v60, v84
  v_mul_f32 v53, v61, v85
  ds_read_b128 v[76:79], v5 offset:23552
  s_waitcnt lgkmcnt(3)
  v_mfma_f32_32x32x16_bf16 v[32:47], a[80:83], v[64:67], v[32:47]
  v_mul_f32 v54, v62, v86
  v_mul_f32 v55, v63, v87
  v_cvt_pk_bf16_f32 v88, v48, v49
  v_cvt_pk_bf16_f32 v89, v50, v51
  buffer_load_dword v7, v3, s[40:43], s76 offen sc1
  ds_read_b128 v[64:67], v5 offset:24576
  s_waitcnt lgkmcnt(3)
  v_mfma_f32_32x32x16_bf16 v[32:47], a[84:87], v[68:71], v[32:47]
  v_cvt_pk_bf16_f32 v90, v52, v53
  v_cvt_pk_bf16_f32 v91, v54, v55
  s_add_u32 s56, s7, 114688
  buffer_store_dwordx4 v[88:91], v1, s[40:43], s56 offen sc1
  ds_read_b128 v[68:71], v5 offset:25600
  s_waitcnt lgkmcnt(3)
  v_mfma_f32_32x32x16_bf16 v[32:47], a[88:91], v[72:75], v[32:47]
  ds_read_b128 v[72:75], v5 offset:26624
  s_waitcnt lgkmcnt(3)
  v_mfma_f32_32x32x16_bf16 v[32:47], a[92:95], v[76:79], v[32:47]
  ds_read_b128 v[76:79], v5 offset:27648
  s_waitcnt lgkmcnt(3)
  v_mfma_f32_32x32x16_bf16 v[32:47], a[96:99], v[64:67], v[32:47]
  ds_read_b128 v[64:67], v5 offset:28672
  s_waitcnt lgkmcnt(3)
  v_mfma_f32_32x32x16_bf16 v[32:47], a[100:103], v[68:71], v[32:47]
  ds_read_b128 v[68:71], v5 offset:29696
  s_waitcnt lgkmcnt(3)
  v_mfma_f32_32x32x16_bf16 v[32:47], a[104:107], v[72:75], v[32:47]
  ds_read_b128 v[72:75], v5 offset:30720
  s_waitcnt lgkmcnt(3)
  v_mfma_f32_32x32x16_bf16 v[32:47], a[108:111], v[76:79], v[32:47]
  ds_read_b128 v[76:79], v5 offset:31744
  s_waitcnt lgkmcnt(3)
  v_mfma_f32_32x32x16_bf16 v[32:47], a[112:115], v[64:67], v[32:47]
  ds_read_b128 v[84:87], v0 offset:31744
  ds_read_b128 v[64:67], v5 offset:32768
  s_waitcnt lgkmcnt(4)
  v_mfma_f32_32x32x16_bf16 v[32:47], a[116:119], v[68:71], v[32:47]
  ds_read_b128 v[68:71], v5 offset:33792
  s_waitcnt lgkmcnt(4)
  v_mfma_f32_32x32x16_bf16 v[32:47], a[120:123], v[72:75], v[32:47]
  s_waitcnt lgkmcnt(2)
  v_mfma_f32_32x32x16_bf16 v[32:47], v[92:95], v[84:87], v[32:47]
  ds_read_b128 v[72:75], v5 offset:34816
  v_mfma_f32_32x32x16_bf16 v[32:47], a[124:127], v[76:79], v[32:47]
  ds_read_b64 v[124:125], v0 offset:1032
  ds_read_b32 v88, v0 offset:1028
  ds_read_b128 v[76:79], v5 offset:35840
  s_waitcnt lgkmcnt(5)
  v_mfma_f32_32x32x16_bf16 v[48:63], a[0:3], v[64:67], 0
  s_waitcnt vmcnt(1)
  v_cmp_ne_u32 vcc, s49, v7
  s_cbranch_vccz L_ok_34
  s_mov_b32 s58, 0x80000
L_pl_35:
  buffer_load_dword v7, v3, s[40:43], s76 offen sc1
  s_waitcnt vmcnt(0)
  s_sub_u32 s58, s58, 1
  s_cmp_eq_u32 s58, 0
  s_cbranch_scc1 L_pd_36
  v_cmp_ne_u32 vcc, s49, v7
  s_cbranch_vccnz L_pl_35
L_pd_36:
L_ok_34:
  s_add_u32 s76, s76, 32768
  ds_read_b128 v[64:67], v5 offset:36864
  s_waitcnt lgkmcnt(5)
  v_mfma_f32_32x32x16_bf16 v[48:63], a[4:7], v[68:71], v[48:63]
  s_barrier
  ds_read_b128 v[68:71], v5 offset:37888
  s_waitcnt lgkmcnt(5)
  v_mfma_f32_32x32x16_bf16 v[48:63], a[8:11], v[72:75], v[48:63]
  s_add_u32 m0, s83, 65536
  s_add_u32 s57, s66, 12288
  buffer_load_dwordx4 v1, s[40:43], s57 offen offset:0 sc1 lds
  ds_read_b128 v[72:75], v5 offset:38912
  s_waitcnt lgkmcnt(3)
  v_mfma_f32_32x32x16_bf16 v[48:63], a[12:15], v[76:79], v[48:63]
  v_mul_f32 v80, v32, v32
  v_mul_f32 v81, v33, v33
  v_mul_f32 v82, v34, v34
  v_mul_f32 v83, v35, v35
  ds_read_b128 v[76:79], v5 offset:39936
  s_waitcnt lgkmcnt(3)
  v_mfma_f32_32x32x16_bf16 v[48:63], a[16:19], v[64:67], v[48:63]
  v_mul_f32 v84, v36, v36
  v_mul_f32 v85, v37, v37
  v_mul_f32 v86, v38, v38
  s_add_u32 m0, s83, 65536
  s_add_u32 s57, s66, 12288
  buffer_load_dwordx4 v1, s[40:43], s57 offen offset:1024 sc1 lds
  ds_read_b128 v[64:67], v5 offset:40960
  s_waitcnt lgkmcnt(3)
  v_mfma_f32_32x32x16_bf16 v[48:63], a[20:23], v[68:71], v[48:63]
  v_mul_f32 v87, v39, v39
  v_mul_f32 v40, v32, v40
  v_mul_f32 v41, v33, v41
  ds_read_b128 v[68:71], v5 offset:41984
  s_waitcnt lgkmcnt(3)
  v_mfma_f32_32x32x16_bf16 v[48:63], a[24:27], v[72:75], v[48:63]
  v_mul_f32 v42, v34, v42
  v_mul_f32 v43, v35, v43
  v_mul_f32 v44, v36, v44
  v_mul_f32 v45, v37, v45
  s_add_u32 m0, s83, 67584
  s_add_u32 s57, s66, 14336
  buffer_load_dwordx4 v1, s[40:43], s57 offen offset:0 sc1 lds
  ds_read_b128 v[72:75], v5 offset:43008
  s_waitcnt lgkmcnt(3)
  v_mfma_f32_32x32x16_bf16 v[48:63], a[28:31], v[76:79], v[48:63]
  v_mul_f32 v46, v38, v46
  v_mul_f32 v47, v39, v47
  s_add_u32 s57, s75, 0
  buffer_load_dwordx4 a[0:3], v126, s[40:43], s57 offen offset:0 sc1
  ds_read_b128 v[76:79], v5 offset:44032
  s_waitcnt lgkmcnt(3)
  v_mfma_f32_32x32x16_bf16 v[48:63], a[32:35], v[64:67], v[48:63]
  v_fma_f32 v80, v80, v125, v124
  v_fma_f32 v81, v81, v125, v124
  v_fma_f32 v82, v82, v125, v124
  s_waitcnt vmcnt(4)
  v_mov_b32 v7, s49
  s_add_u32 s59, s67, 98304
  s_mov_b64 exec, 1
  s_cmp_eq_u32 s64, 0
  s_cbranch_scc1 L_sl_32
  buffer_store_dword v7, off, s[40:43], s59
L_sj_33:
  s_mov_b64 exec, -1
  s_add_u32 m0, s83, 67584
  s_add_u32 s57, s66, 14336
  buffer_load_dwordx4 v1, s[40:43], s57 offen offset:1024 sc1 lds
  ds_read_b128 v[64:67], v5 offset:45056
  s_waitcnt lgkmcnt(3)
  v_mfma_f32_32x32x16_bf16 v[48:63], a[36:39], v[68:71], v[48:63]
  v_fma_f32 v83, v83, v125, v124
  v_fma_f32 v84, v84, v125, v124
  v_fma_f32 v85, v85, v125, v124
  v_fma_f32 v86, v86, v125, v124
  s_add_u32 s57, s75, 0
  buffer_load_dwordx4 a[4:7], v126, s[40:43], s57 offen offset:2048 sc1
  ds_read_b128 v[68:71], v5 offset:46080
  s_waitcnt lgkmcnt(3)
  v_mfma_f32_32x32x16_bf16 v[48:63], a[40:43], v[72:75], v[48:63]
  v_fma_f32 v87, v87, v125, v124
  v_mul_f32 v80, v80, v32
  v_mul_f32 v81, v81, v33
  ds_read_b128 v[72:75], v5 offset:47104
  s_waitcnt lgkmcnt(3)
  v_mfma_f32_32x32x16_bf16 v[48:63], a[44:47], v[76:79], v[48:63]
  v_mul_f32 v82, v82, v34
  v_mul_f32 v83, v83, v35
  v_mul_f32 v84, v84, v36
  s_add_u32 s57, s75, 4096
  buffer_load_dwordx4 a[8:11], v126, s[40:43], s57 offen offset:0 sc1
  ds_read_b128 v[76:79], v5 offset:48128
  s_waitcnt lgkmcnt(3)
  v_mfma_f32_32x32x16_bf16 v[48:63], a[48:51], v[64:67], v[48:63]
  v_mul_f32 v85, v85, v37
  v_mul_f32 v86, v86, v38
  v_mul_f32 v87, v87, v39
  v_exp_f32 v80, v80
  ds_read_b128 v[64:67], v5 offset:49152
  s_waitcnt lgkmcnt(3)
  v_mfma_f32_32x32x16_bf16 v[48:63], a[52:55], v[68:71], v[48:63]
  v_exp_f32 v81, v81
  v_exp_f32 v82, v82
  v_exp_f32 v83, v83
  s_add_u32 s57, s75, 4096
  buffer_load_dwordx4 a[12:15], v126, s[40:43], s57 offen offset:2048 sc1
  ds_read_b128 v[68:71], v5 offset:50176
  s_waitcnt lgkmcnt(3)
  v_mfma_f32_32x32x16_bf16 v[48:63], a[56:59], v[72:75], v[48:63]
  v_exp_f32 v84, v84
  v_exp_f32 v85, v85
  v_exp_f32 v86, v86
  s_add_u32 s57, s75, 8192
  buffer_load_dwordx4 a[16:19], v126, s[40:43], s57 offen offset:0 sc1
  ds_read_b128 v[72:75], v5 offset:51200
  s_waitcnt lgkmcnt(3)
  v_mfma_f32_32x32x16_bf16 v[48:63], a[60:63], v[76:79], v[48:63]
  v_exp_f32 v87, v87
  v_fma_f32 v80, v80, v88, v88
  v_fma_f32 v81, v81, v88, v88
  v_fma_f32 v82, v82, v88, v88
  ds_read_b128 v[76:79], v5 offset:52224
  s_waitcnt lgkmcnt(3)
  v_mfma_f32_32x32x16_bf16 v[48:63], a[64:67], v[64:67], v[48:63]
  v_fma_f32 v83, v83, v88, v88
  v_fma_f32 v84, v84, v88, v88
  v_fma_f32 v85, v85, v88, v88
  s_add_u32 s57, s75, 8192
  buffer_load_dwordx4 a[20:23], v126, s[40:43], s57 offen offset:2048 sc1
  ds_read_b128 v[64:67], v5 offset:53248
  s_waitcnt lgkmcnt(3)
  v_mfma_f32_32x32x16_bf16 v[48:63], a[68:71], v[68:71], v[48:63]
  v_fma_f32 v86, v86, v88, v88
  v_fma_f32 v87, v87, v88, v88
  v_rcp_f32 v80, v80
  ds_read_b128 a[64:67], v2 offset:0
  ds_read_b128 a[68:71], v2 offset:256
  ds_read_b128 v[68:71], v5 offset:54272
  s_waitcnt lgkmcnt(5)
  v_mfma_f32_32x32x16_bf16 v[48:63], a[72:75], v[72:75], v[48:63]
  v_rcp_f32 v81, v81
  v_rcp_f32 v82, v82
  v_rcp_f32 v83, v83
  v_rcp_f32 v84, v84
  s_add_u32 s57, s75, 12288
  buffer_load_dwordx4 a[24:27], v126, s[40:43], s57 offen offset:0 sc1
  ds_read_b128 v[72:75], v5 offset:55296
  s_waitcnt lgkmcnt(5)
  v_mfma_f32_32x32x16_bf16 v[48:63], a[76:79], v[76:79], v[48:63]
  v_rcp_f32 v85, v85
  v_rcp_f32 v86, v86
  v_rcp_f32 v87, v87
  ds_read_b128 a[72:75], v2 offset:1024
  ds_read_b128 a[76:79], v2 offset:1280
  ds_read_b128 v[76:79], v5 offset:56320
  s_waitcnt lgkmcnt(7)
  v_mfma_f32_32x32x16_bf16 v[48:63], a[80:83], v[64:67], v[48:63]
  v_mul_f32 v32, v40, v80
  v_mul_f32 v33, v41, v81
  v_mul_f32 v34, v42, v82
  ds_read_b128 v[64:67], v5 offset:57344
  s_waitcnt lgkmcnt(5)
  v_mfma_f32_32x32x16_bf16 v[48:63], a[84:87], v[68:71], v[48:63]
  v_mul_f32 v35, v43, v83
  v_mul_f32 v36, v44, v84
  v_mul_f32 v37, v45, v85
  v_mul_f32 v38, v46, v86
  ds_read_b128 a[80:83], v4 offset:0
  ds_read_b128 a[84:87], v4 offset:256
  ds_read_b128 v[68:71], v5 offset:58368
  s_waitcnt lgkmcnt(7)
  v_mfma_f32_32x32x16_bf16 v[48:63], a[88:91], v[72:75], v[48:63]
  v_mul_f32 v39, v47, v87
  v_cvt_pk_bf16_f32 v88, v32, v33
  v_cvt_pk_bf16_f32 v89, v34, v35
  buffer_load_dword v7, v3, s[40:43], s76 offen sc1
  ds_read_b128 v[72:75], v5 offset:59392
  s_waitcnt lgkmcnt(5)
  v_mfma_f32_32x32x16_bf16 v[48:63], a[92:95], v[76:79], v[48:63]
  v_cvt_pk_bf16_f32 v90, v36, v37
  v_cvt_pk_bf16_f32 v91, v38, v39
  s_add_u32 s56, s96, 2097152
  s_cmp_eq_u32 s64, 0
  s_cbranch_scc1 L_sl_28
  buffer_store_dwordx4 v[88:91], v1, s[40:43], s56 offen
L_sj_29:
  ds_read_b128 a[88:91], v4 offset:1024
  ds_read_b128 a[92:95], v4 offset:1280
  ds_read_b128 v[76:79], v5 offset:60416
  s_waitcnt lgkmcnt(7)
  v_mfma_f32_32x32x16_bf16 v[48:63], a[96:99], v[64:67], v[48:63]
  ds_read_b128 v[64:67], v5 offset:61440
  s_waitcnt lgkmcnt(5)
  v_mfma_f32_32x32x16_bf16 v[48:63], a[100:103], v[68:71], v[48:63]
  ds_read_b128 a[96:99], v4 offset:32768
  ds_read_b128 a[100:103], v4 offset:33024
  ds_read_b128 v[68:71], v5 offset:62464
  s_waitcnt lgkmcnt(7)
  v_mfma_f32_32x32x16_bf16 v[48:63], a[104:107], v[72:75], v[48:63]
  ds_read_b128 v[72:75], v5 offset:63488
  s_waitcnt lgkmcnt(5)
  v_mfma_f32_32x32x16_bf16 v[48:63], a[108:111], v[76:79], v[48:63]
  ds_read_b128 a[104:107], v4 offset:33792
  ds_read_b128 a[108:111], v4 offset:34048
  ds_read_b128 v[76:79], v5 offset:64512
  s_waitcnt lgkmcnt(7)
  v_mfma_f32_32x32x16_bf16 v[48:63], a[112:115], v[64:67], v[48:63]
  ds_read_b128 v[84:87], v0 offset:32256
  s_waitcnt lgkmcnt(5)
  v_mfma_f32_32x32x16_bf16 v[48:63], a[116:119], v[68:71], v[48:63]
  s_waitcnt vmcnt(8)
  ds_read_b128 a[112:115], v6 offset:0
  ds_read_b128 a[116:119], v6 offset:256
  s_waitcnt lgkmcnt(6)
  v_mfma_f32_32x32x16_bf16 v[48:63], a[120:123], v[72:75], v[48:63]
  s_waitcnt lgkmcnt(2)
  v_mfma_f32_32x32x16_bf16 v[48:63], v[92:95], v[84:87], v[48:63]
  ds_read_b64 v[124:125], v0 offset:1544
  ds_read_b32 v88, v0 offset:1540
  v_mfma_f32_32x32x16_bf16 v[48:63], a[124:127], v[76:79], v[48:63]
  ds_read_b128 a[120:123], v6 offset:1024
  ds_read_b128 a[124:127], v6 offset:1280
  s_waitcnt vmcnt(1)
  v_cmp_ne_u32 vcc, s49, v7
  s_cbranch_vccz L_ok_39
  s_mov_b32 s58, 0x80000
L_pl_40:
  buffer_load_dword v7, v3, s[40:43], s76 offen sc1
  s_waitcnt vmcnt(0)
  s_sub_u32 s58, s58, 1
  s_cmp_eq_u32 s58, 0
  s_cbranch_scc1 L_pd_41
  v_cmp_ne_u32 vcc, s49, v7
  s_cbranch_vccnz L_pl_40
L_pd_41:
L_ok_39:
  s_add_u32 s76, s76, 32768
  s_nop 5
  v_mul_f32 v80, v48, v48
  s_waitcnt vmcnt(0)
  v_mov_b32 v7, s49
  s_add_u32 s59, s67, 131072
  s_mov_b64 exec, 1
  s_cmp_eq_u32 s64, 0
  s_cbranch_scc1 L_sl_42
  buffer_store_dword v7, off, s[40:43], s59
L_sj_43:
  s_mov_b64 exec, -1
  v_mul_f32 v81, v49, v49
  v_mul_f32 v82, v50, v50
  v_mul_f32 v83, v51, v51
  v_mul_f32 v84, v52, v52
  v_mul_f32 v85, v53, v53
  v_mul_f32 v86, v54, v54
  s_add_u32 s57, s75, 114688
  buffer_load_dwordx4 a[28:31], v126, s[40:43], s57 offen offset:0 sc1
  v_mul_f32 v87, v55, v55
  v_mul_f32 v56, v48, v56
  v_mul_f32 v57, v49, v57
  v_mul_f32 v58, v50, v58
  v_mul_f32 v59, v51, v59
  v_mul_f32 v60, v52, v60
  v_mul_f32 v61, v53, v61
  v_mul_f32 v62, v54, v62
  v_mul_f32 v63, v55, v63
  s_add_u32 s57, s75, 114688
  buffer_load_dwordx4 a[32:35], v126, s[40:43], s57 offen offset:2048 sc1
  s_waitcnt lgkmcnt(2)
  v_fma_f32 v80, v80, v125, v124
  v_fma_f32 v81, v81, v125, v124
  v_fma_f32 v82, v82, v125, v124
  v_fma_f32 v83, v83, v125, v124
  v_fma_f32 v84, v84, v125, v124
  v_fma_f32 v85, v85, v125, v124
  v_fma_f32 v86, v86, v125, v124
  v_fma_f32 v87, v87, v125, v124
  s_add_u32 s57, s75, 118784
  buffer_load_dwordx4 a[36:39], v126, s[40:43], s57 offen offset:0 sc1
  v_mul_f32 v80, v80, v48
  v_mul_f32 v81, v81, v49
  v_mul_f32 v82, v82, v50
  v_mul_f32 v83, v83, v51
  v_mul_f32 v84, v84, v52
  v_mul_f32 v85, v85, v53
  v_mul_f32 v86, v86, v54
  v_mul_f32 v87, v87, v55
  v_exp_f32 v80, v80
  s_add_u32 s57, s75, 118784
  buffer_load_dwordx4 a[40:43], v126, s[40:43], s57 offen offset:2048 sc1
  v_exp_f32 v81, v81
  v_exp_f32 v82, v82
  v_exp_f32 v83, v83
  v_exp_f32 v84, v84
  v_exp_f32 v85, v85
  v_exp_f32 v86, v86
  v_exp_f32 v87, v87
  v_fma_f32 v80, v80, v88, v88
  v_fma_f32 v81, v81, v88, v88
  s_add_u32 s57, s75, 122880
  buffer_load_dwordx4 a[44:47], v126, s[40:43], s57 offen offset:0 sc1
  v_fma_f32 v82, v82, v88, v88
  v_fma_f32 v83, v83, v88, v88
  v_fma_f32 v84, v84, v88, v88
  v_fma_f32 v85, v85, v88, v88
  v_fma_f32 v86, v86, v88, v88
  v_fma_f32 v87, v87, v88, v88
  v_rcp_f32 v80, v80
  v_rcp_f32 v81, v81
  v_rcp_f32 v82, v82
  s_add_u32 s57, s75, 122880
  buffer_load_dwordx4 a[48:51], v126, s[40:43], s57 offen offset:2048 sc1
  v_rcp_f32 v83, v83
  v_rcp_f32 v84, v84
  v_rcp_f32 v85, v85
  v_rcp_f32 v86, v86
  v_rcp_f32 v87, v87
  v_mul_f32 v48, v56, v80
  v_mul_f32 v49, v57, v81
  v_mul_f32 v50, v58, v82
  v_mul_f32 v51, v59, v83
  s_add_u32 s57, s75, 126976
  buffer_load_dwordx4 a[52:55], v126, s[40:43], s57 offen offset:0 sc1
  v_mul_f32 v52, v60, v84
  v_mul_f32 v53, v61, v85
  v_mul_f32 v54, v62, v86
  v_mul_f32 v55, v63, v87
  v_cvt_pk_bf16_f32 v88, v48, v49
  v_cvt_pk_bf16_f32 v89, v50, v51
  v_cvt_pk_bf16_f32 v90, v52, v53
  v_cvt_pk_bf16_f32 v91, v54, v55
  s_cmp_eq_u32 s64, 0
  s_cbranch_scc1 L_sl_37
  buffer_store_dwordx4 v[88:91], v1, s[40:43], s96 offen
L_sj_38:
  s_branch L_gu_j
L_gu_w7:
  v_and_b32 v124, 0xf0, v1
  v_lshlrev_b32 v124, 1, v124
  v_add_u32 v124, 131072, v124
  s_lshl_b32 s54, s45, 14
  s_add_u32 s54, s54, 1310720
  buffer_load_dwordx4 v[32:35], v1, s[40:43], s54 offen offset:0 sc1
  buffer_load_dwordx4 v[36:39], v1, s[40:43], s54 offen offset:1024 sc1
  buffer_load_dwordx4 v[40:43], v1, s[40:43], s54 offen offset:2048 sc1
  buffer_load_dwordx4 v[44:47], v1, s[40:43], s54 offen offset:3072 sc1
  s_add_u32 s54, s54, 4096
  buffer_load_dwordx4 v[48:51], v1, s[40:43], s54 offen offset:0 sc1
  buffer_load_dwordx4 v[52:55], v1, s[40:43], s54 offen offset:1024 sc1
  buffer_load_dwordx4 v[56:59], v1, s[40:43], s54 offen offset:2048 sc1
  buffer_load_dwordx4 v[60:63], v1, s[40:43], s54 offen offset:3072 sc1
  s_add_u32 s54, s54, 4096
  s_waitcnt vmcnt(4)
  v_add_f32 v32, v32, v36
  v_add_f32 v33, v33, v37
  v_add_f32 v34, v34, v38
  v_add_f32 v35, v35, v39
  v_add_f32 v32, v32, v40
  v_add_f32 v33, v33, v41
  v_add_f32 v34, v34, v42
  v_add_f32 v35, v35, v43
  v_add_f32 v32, v32, v44
  v_add_f32 v33, v33, v45
  v_add_f32 v34, v34, v46
  v_add_f32 v35, v35, v47
  v_mov_b32 v36, v32
  v_mov_b32 v37, v33
  v_mov_b32 v38, v34
  v_mov_b32 v39, v35
  v_permlane16_swap_b32 v32, v36
  v_permlane16_swap_b32 v33, v37
  v_permlane16_swap_b32 v34, v38
  v_permlane16_swap_b32 v35, v39
  v_add_f32 v32, v32, v36
  v_add_f32 v33, v33, v37
  v_add_f32 v34, v34, v38
  v_add_f32 v35, v35, v39
  v_mov_b32 v36, v32
  v_mov_b32 v37, v33
  v_mov_b32 v38, v34
  v_mov_b32 v39, v35
  v_permlane32_swap_b32 v32, v36
  v_permlane32_swap_b32 v33, v37
  v_permlane32_swap_b32 v34, v38
  v_permlane32_swap_b32 v35, v39
  v_add_f32 v32, v32, v36
  v_add_f32 v33, v33, v37
  v_add_f32 v34, v34, v38
  v_add_f32 v35, v35, v39
  v_mov_b32 v41, v33
  v_mul_f32 v40, 0x3b000000, v32
  v_mul_f32 v41, 0x3b000000, v41
  v_fma_f32 v41, -v40, v40, v41
  v_max_f32 v41, 0, v41
  v_add_f32 v41, 0x3727c5ac, v41
  v_rsq_f32 v42, v41
  s_nop 0
  v_mul_f32 v43, v42, v42
  v_mul_f32 v43, v43, v42
  v_mul_f32 v42, 0xc0135761, v42
  v_mul_f32 v43, 0xbdd2d3e8, v43
  ds_write_b128 v124, v[40:43] offset:0
  v_cvt_pk_bf16_f32 v36, -v40, -v40
  v_and_b32 v37, s61, v36
  v_sub_f32 v37, -v40, v37
  v_cvt_pk_bf16_f32 v37, v37, 0
  v_mov_b32 v38, 0
  v_mov_b32 v39, 0
  ds_write_b128 v124, v[36:39] offset:30720
  v_mov_b32 v45, v35
  v_mul_f32 v44, 0x3b000000, v34
  v_mul_f32 v45, 0x3b000000, v45
  v_fma_f32 v45, -v44, v44, v45
  v_max_f32 v45, 0, v45
  v_add_f32 v45, 0x3727c5ac, v45
  v_rsq_f32 v46, v45
  s_nop 0
  v_mul_f32 v47, v46, v46
  v_mul_f32 v47, v47, v46
  v_mul_f32 v46, 0xc0135761, v46
  v_mul_f32 v47, 0xbdd2d3e8, v47
  ds_write_b128 v124, v[44:47] offset:16
  v_cvt_pk_bf16_f32 v36, -v44, -v44
  v_and_b32 v37, s61, v36
  v_sub_f32 v37, -v44, v37
  v_cvt_pk_bf16_f32 v37, v37, 0
  v_mov_b32 v38, 0
  v_mov_b32 v39, 0
  ds_write_b128 v124, v[36:39] offset:30736
  s_add_u32 m0, s83, 65536
  s_add_u32 s55, s72, 65536
  buffer_load_dwordx4 v1, s[40:43], s55 offen offset:0 sc1 lds
  s_add_u32 m0, s83, 65536
  s_add_u32 s55, s72, 65536
  buffer_load_dwordx4 v1, s[40:43], s55 offen offset:1024 sc1 lds
  s_add_u32 m0, s83, 65536
  s_add_u32 s55, s72, 65536
  buffer_load_dwordx4 v1, s[40:43], s55 offen offset:2048 sc1 lds
  s_add_u32 m0, s83, 65536
  s_add_u32 s55, s72, 65536
  buffer_load_dwordx4 v1, s[40:43], s55 offen offset:3072 sc1 lds
  s_waitcnt lgkmcnt(0)
  s_barrier
  s_add_u32 m0, s83, 98304
  s_add_u32 s55, s72, 98304
  buffer_load_dwordx4 v1, s[40:43], s55 offen offset:0 sc1 lds
  s_add_u32 m0, s83, 98304
  s_add_u32 s55, s72, 98304
  buffer_load_dwordx4 v1, s[40:43], s55 offen offset:1024 sc1 lds
  s_add_u32 m0, s83, 98304
  s_add_u32 s55, s72, 98304
  buffer_load_dwordx4 v1, s[40:43], s55 offen offset:2048 sc1 lds
  s_add_u32 m0, s83, 98304
  s_add_u32 s55, s72, 98304
  buffer_load_dwordx4 v1, s[40:43], s55 offen offset:3072 sc1 lds
  buffer_load_dwordx4 v[64:67], v1, s[40:43], s54 offen offset:0 sc1
  buffer_load_dwordx4 v[68:71], v1, s[40:43], s54 offen offset:1024 sc1
  buffer_load_dwordx4 v[72:75], v1, s[40:43], s54 offen offset:2048 sc1
  buffer_load_dwordx4 v[76:79], v1, s[40:43], s54 offen offset:3072 sc1
  s_add_u32 s54, s54, 4096
  buffer_load_dwordx4 v[80:83], v1, s[40:43], s54 offen offset:0 sc1
  buffer_load_dwordx4 v[84:87], v1, s[40:43], s54 offen offset:1024 sc1
  buffer_load_dwordx4 v[88:91], v1, s[40:43], s54 offen offset:2048 sc1
  buffer_load_dwordx4 v[92:95], v1, s[40:43], s54 offen offset:3072 sc1
  s_add_u32 s54, s54, 4096
  s_add_u32 s57, s74, 65536
  buffer_load_dwordx2 v[112:113], v114, s[40:43], s74 offen sc1
  buffer_load_dwordx2 v[114:115], v114, s[40:43], s57 offen sc1
  s_waitcnt vmcnt(18)
  v_add_f32 v48, v48, v52
  v_add_f32 v49, v49, v53
  v_add_f32 v50, v50, v54
  v_add_f32 v51, v51, v55
  v_add_f32 v48, v48, v56
  v_add_f32 v49, v49, v57
  v_add_f32 v50, v50, v58
  v_add_f32 v51, v51, v59
  v_add_f32 v48, v48, v60
  v_add_f32 v49, v49, v61
  v_add_f32 v50, v50, v62
  v_add_f32 v51, v51, v63
  v_mov_b32 v52, v48
  v_mov_b32 v53, v49
  v_mov_b32 v54, v50
  v_mov_b32 v55, v51
  v_permlane16_swap_b32 v48, v52
  v_permlane16_swap_b32 v49, v53
  v_permlane16_swap_b32 v50, v54
  v_permlane16_swap_b32 v51, v55
  v_add_f32 v48, v48, v52
  v_add_f32 v49, v49, v53
  v_add_f32 v50, v50, v54
  v_add_f32 v51, v51, v55
  v_mov_b32 v52, v48
  v_mov_b32 v53, v49
  v_mov_b32 v54, v50
  v_mov_b32 v55, v51
  v_permlane32_swap_b32 v48, v52
  v_permlane32_swap_b32 v49, v53
  v_permlane32_swap_b32 v50, v54
  v_permlane32_swap_b32 v51, v55
  v_add_f32 v48, v48, v52
  v_add_f32 v49, v49, v53
  v_add_f32 v50, v50, v54
  v_add_f32 v51, v51, v55
  v_mov_b32 v57, v49
  v_mul_f32 v56, 0x3b000000, v48
  v_mul_f32 v57, 0x3b000000, v57
  v_fma_f32 v57, -v56, v56, v57
  v_max_f32 v57, 0, v57
  v_add_f32 v57, 0x3727c5ac, v57
  v_rsq_f32 v58, v57
  s_nop 0
  v_mul_f32 v59, v58, v58
  v_mul_f32 v59, v59, v58
  v_mul_f32 v58, 0xc0135761, v58
  v_mul_f32 v59, 0xbdd2d3e8, v59
  ds_write_b128 v124, v[56:59] offset:512
  v_cvt_pk_bf16_f32 v52, -v56, -v56
  v_and_b32 v53, s61, v52
  v_sub_f32 v53, -v56, v53
  v_cvt_pk_bf16_f32 v53, v53, 0
  v_mov_b32 v54, 0
  v_mov_b32 v55, 0
  ds_write_b128 v124, v[52:55] offset:31232
  v_mov_b32 v61, v51
  v_mul_f32 v60, 0x3b000000, v50
  v_mul_f32 v61, 0x3b000000, v61
  v_fma_f32 v61, -v60, v60, v61
  v_max_f32 v61, 0, v61
  v_add_f32 v61, 0x3727c5ac, v61
  v_rsq_f32 v62, v61
  s_nop 0
  v_mul_f32 v63, v62, v62
  v_mul_f32 v63, v63, v62
  v_mul_f32 v62, 0xc0135761, v62
  v_mul_f32 v63, 0xbdd2d3e8, v63
  ds_write_b128 v124, v[60:63] offset:528
  v_cvt_pk_bf16_f32 v52, -v60, -v60
  v_and_b32 v53, s61, v52
  v_sub_f32 v53, -v60, v53
  v_cvt_pk_bf16_f32 v53, v53, 0
  v_mov_b32 v54, 0
  v_mov_b32 v55, 0
  ds_write_b128 v124, v[52:55] offset:31248
  s_waitcnt vmcnt(6)
  v_add_f32 v64, v64, v68
  v_add_f32 v65, v65, v69
  v_add_f32 v66, v66, v70
  v_add_f32 v67, v67, v71
  v_add_f32 v64, v64, v72
  v_add_f32 v65, v65, v73
  v_add_f32 v66, v66, v74
  v_add_f32 v67, v67, v75
  v_add_f32 v64, v64, v76
  v_add_f32 v65, v65, v77
  v_add_f32 v66, v66, v78
  v_add_f32 v67, v67, v79
  v_mov_b32 v68, v64
  v_mov_b32 v69, v65
  v_mov_b32 v70, v66
  v_mov_b32 v71, v67
  v_permlane16_swap_b32 v64, v68
  v_permlane16_swap_b32 v65, v69
  v_permlane16_swap_b32 v66, v70
  v_permlane16_swap_b32 v67, v71
  v_add_f32 v64, v64, v68
  v_add_f32 v65, v65, v69
  v_add_f32 v66, v66, v70
  v_add_f32 v67, v67, v71
  v_mov_b32 v68, v64
  v_mov_b32 v69, v65
  v_mov_b32 v70, v66
  v_mov_b32 v71, v67
  v_permlane32_swap_b32 v64, v68
  v_permlane32_swap_b32 v65, v69
  v_permlane32_swap_b32 v66, v70
  v_permlane32_swap_b32 v67, v71
  v_add_f32 v64, v64, v68
  v_add_f32 v65, v65, v69
  v_add_f32 v66, v66, v70
  v_add_f32 v67, v67, v71
  v_mov_b32 v73, v65
  v_mul_f32 v72, 0x3b000000, v64
  v_mul_f32 v73, 0x3b000000, v73
  v_fma_f32 v73, -v72, v72, v73
  v_max_f32 v73, 0, v73
  v_add_f32 v73, 0x3727c5ac, v73
  v_rsq_f32 v74, v73
  s_nop 0
  v_mul_f32 v75, v74, v74
  v_mul_f32 v75, v75, v74
  v_mul_f32 v74, 0xc0135761, v74
  v_mul_f32 v75, 0xbdd2d3e8, v75
  ds_write_b128 v124, v[72:75] offset:1024
  v_cvt_pk_bf16_f32 v68, -v72, -v72
  v_and_b32 v69, s61, v68
  v_sub_f32 v69, -v72, v69
  v_cvt_pk_bf16_f32 v69, v69, 0
  v_mov_b32 v70, 0
  v_mov_b32 v71, 0
  ds_write_b128 v124, v[68:71] offset:31744
  v_mov_b32 v77, v67
  v_mul_f32 v76, 0x3b000000, v66
  v_mul_f32 v77, 0x3b000000, v77
  v_fma_f32 v77, -v76, v76, v77
  v_max_f32 v77, 0, v77
  v_add_f32 v77, 0x3727c5ac, v77
  v_rsq_f32 v78, v77
  s_nop 0
  v_mul_f32 v79, v78, v78
  v_mul_f32 v79, v79, v78
  v_mul_f32 v78, 0xc0135761, v78
  v_mul_f32 v79, 0xbdd2d3e8, v79
  ds_write_b128 v124, v[76:79] offset:1040
  v_cvt_pk_bf16_f32 v68, -v76, -v76
  v_and_b32 v69, s61, v68
  v_sub_f32 v69, -v76, v69
  v_cvt_pk_bf16_f32 v69, v69, 0
  v_mov_b32 v70, 0
  v_mov_b32 v71, 0
  ds_write_b128 v124, v[68:71] offset:31760
  s_waitcnt vmcnt(0) lgkmcnt(0)
  s_barrier
  s_barrier
  v_add_f32 v80, v80, v84
  v_add_f32 v81, v81, v85
  v_add_f32 v82, v82, v86
  v_add_f32 v83, v83, v87
  v_add_f32 v80, v80, v88
  v_add_f32 v81, v81, v89
  v_add_f32 v82, v82, v90
  v_add_f32 v83, v83, v91
  v_add_f32 v80, v80, v92
  v_add_f32 v81, v81, v93
  v_add_f32 v82, v82, v94
  v_add_f32 v83, v83, v95
  v_mov_b32 v84, v80
  v_mov_b32 v85, v81
  v_mov_b32 v86, v82
  v_mov_b32 v87, v83
  v_permlane16_swap_b32 v80, v84
  v_permlane16_swap_b32 v81, v85
  v_permlane16_swap_b32 v82, v86
  v_permlane16_swap_b32 v83, v87
  v_add_f32 v80, v80, v84
  v_add_f32 v81, v81, v85
  v_add_f32 v82, v82, v86
  v_add_f32 v83, v83, v87
  v_mov_b32 v84, v80
  v_mov_b32 v85, v81
  v_mov_b32 v86, v82
  v_mov_b32 v87, v83
  v_permlane32_swap_b32 v80, v84
  v_permlane32_swap_b32 v81, v85
  v_permlane32_swap_b32 v82, v86
  v_permlane32_swap_b32 v83, v87
  v_add_f32 v80, v80, v84
  v_add_f32 v81, v81, v85
  v_add_f32 v82, v82, v86
  v_add_f32 v83, v83, v87
  v_mov_b32 v89, v81
  v_mul_f32 v88, 0x3b000000, v80
  v_mul_f32 v89, 0x3b000000, v89
  v_fma_f32 v89, -v88, v88, v89
  v_max_f32 v89, 0, v89
  v_add_f32 v89, 0x3727c5ac, v89
  v_rsq_f32 v90, v89
  s_nop 0
  v_mul_f32 v91, v90, v90
  v_mul_f32 v91, v91, v90
  v_mul_f32 v90, 0xc0135761, v90
  v_mul_f32 v91, 0xbdd2d3e8, v91
  ds_write_b128 v124, v[88:91] offset:1536
  v_cvt_pk_bf16_f32 v84, -v88, -v88
  v_and_b32 v85, s61, v84
  v_sub_f32 v85, -v88, v85
  v_cvt_pk_bf16_f32 v85, v85, 0
  v_mov_b32 v86, 0
  v_mov_b32 v87, 0
  ds_write_b128 v124, v[84:87] offset:32256
  v_mov_b32 v93, v83
  v_mul_f32 v92, 0x3b000000, v82
  v_mul_f32 v93, 0x3b000000, v93
  v_fma_f32 v93, -v92, v92, v93
  v_max_f32 v93, 0, v93
  v_add_f32 v93, 0x3727c5ac, v93
  v_rsq_f32 v94, v93
  s_nop 0
  v_mul_f32 v95, v94, v94
  v_mul_f32 v95, v95, v94
  v_mul_f32 v94, 0xc0135761, v94
  v_mul_f32 v95, 0xbdd2d3e8, v95
  ds_write_b128 v124, v[92:95] offset:1552
  v_cvt_pk_bf16_f32 v84, -v92, -v92
  v_and_b32 v85, s61, v84
  v_sub_f32 v85, -v92, v85
  v_cvt_pk_bf16_f32 v85, v85, 0
  v_mov_b32 v86, 0
  v_mov_b32 v87, 0
  ds_write_b128 v124, v[84:87] offset:32272
  s_add_u32 s55, s98, 20480
  buffer_load_dwordx4 v[24:27], v4, s[40:43], s55 offen offset:0 sc1
  s_add_u32 s55, s98, 20480
  buffer_load_dwordx4 v[28:31], v4, s[40:43], s55 offen offset:256 sc1
  s_add_u32 s55, s98, 20480
  buffer_load_dwordx4 v[96:99], v4, s[40:43], s55 offen offset:1024 sc1
  s_add_u32 s55, s98, 20480
  buffer_load_dwordx4 v[100:103], v4, s[40:43], s55 offen offset:1280 sc1
  s_add_u32 s55, s98, 24576
  buffer_load_dwordx4 v[116:119], v4, s[40:43], s55 offen offset:0 sc1
  s_add_u32 s55, s98, 24576
  buffer_load_dwordx4 v[120:123], v4, s[40:43], s55 offen offset:256 sc1
  s_add_u32 s55, s98, 24576
  buffer_load_dwordx4 v[104:107], v4, s[40:43], s55 offen offset:1024 sc1
  s_add_u32 s55, s98, 24576
  buffer_load_dwordx4 v[108:111], v4, s[40:43], s55 offen offset:1280 sc1
  s_add_u32 s55, s98, 0
  buffer_load_dwordx4 a[64:67], v4, s[40:43], s55 offen offset:0 sc1
  s_add_u32 s55, s98, 0
  buffer_load_dwordx4 a[68:71], v4, s[40:43], s55 offen offset:256 sc1
  s_add_u32 s55, s98, 0
  buffer_load_dwordx4 a[72:75], v4, s[40:43], s55 offen offset:1024 sc1
  s_add_u32 s55, s98, 0
  buffer_load_dwordx4 a[76:79], v4, s[40:43], s55 offen offset:1280 sc1
  s_add_u32 s55, s98, 4096
  buffer_load_dwordx4 a[80:83], v4, s[40:43], s55 offen offset:0 sc1
  s_add_u32 s55, s98, 4096
  buffer_load_dwordx4 a[84:87], v4, s[40:43], s55 offen offset:256 sc1
  s_add_u32 s55, s98, 4096
  buffer_load_dwordx4 a[88:91], v4, s[40:43], s55 offen offset:1024 sc1
  s_add_u32 s55, s98, 4096
  buffer_load_dwordx4 a[92:95], v4, s[40:43], s55 offen offset:1280 sc1
  s_waitcnt lgkmcnt(0)
  s_mov_b32 s58, 0x80000
L_pl_44:
  buffer_load_dword v7, v3, s[40:43], s76 offen sc1
  s_waitcnt vmcnt(0)
  s_sub_u32 s58, s58, 1
  s_cmp_eq_u32 s58, 0
  s_cbranch_scc1 L_pd_45
  v_cmp_ne_u32 vcc, s49, v7
  s_cbranch_vccnz L_pl_44
L_pd_45:
  s_add_u32 s76, s76, 32768
  s_barrier
  s_add_u32 s55, s98, 8192
  buffer_load_dwordx4 a[96:99], v4, s[40:43], s55 offen offset:0 sc1
  s_add_u32 s55, s98, 8192
  buffer_load_dwordx4 a[100:103], v4, s[40:43], s55 offen offset:256 sc1
  s_add_u32 s55, s98, 8192
  buffer_load_dwordx4 a[104:107], v4, s[40:43], s55 offen offset:1024 sc1
  s_add_u32 s55, s98, 8192
  buffer_load_dwordx4 a[108:111], v4, s[40:43], s55 offen offset:1280 sc1
  s_add_u32 s55, s98, 12288
  buffer_load_dwordx4 a[112:115], v4, s[40:43], s55 offen offset:0 sc1
  s_add_u32 s55, s98, 12288
  buffer_load_dwordx4 a[116:119], v4, s[40:43], s55 offen offset:256 sc1
  s_add_u32 s55, s98, 12288
  buffer_load_dwordx4 a[120:123], v4, s[40:43], s55 offen offset:1024 sc1
  s_add_u32 s55, s98, 12288
  buffer_load_dwordx4 a[124:127], v4, s[40:43], s55 offen offset:1280 sc1
  s_add_u32 s57, s75, 0
  buffer_load_dwordx4 a[0:3], v126, s[40:43], s57 offen offset:0 sc1
  s_add_u32 s57, s75, 0
  buffer_load_dwordx4 a[4:7], v126, s[40:43], s57 offen offset:2048 sc1
  s_add_u32 s57, s75, 4096
  buffer_load_dwordx4 a[8:11], v126, s[40:43], s57 offen offset:0 sc1
  s_add_u32 s57, s75, 4096
  buffer_load_dwordx4 a[12:15], v126, s[40:43], s57 offen offset:2048 sc1
  s_add_u32 s57, s75, 8192
  buffer_load_dwordx4 a[16:19], v126, s[40:43], s57 offen offset:0 sc1
  s_add_u32 s57, s75, 8192
  buffer_load_dwordx4 a[20:23], v126, s[40:43], s57 offen offset:2048 sc1
  s_add_u32 s57, s75, 12288
  buffer_load_dwordx4 a[24:27], v126, s[40:43], s57 offen offset:0 sc1
  s_mov_b32 s58, 0x80000
L_pl_46:
  buffer_load_dword v7, v3, s[40:43], s76 offen sc1
  s_waitcnt vmcnt(0)
  s_sub_u32 s58, s58, 1
  s_cmp_eq_u32 s58, 0
  s_cbranch_scc1 L_pd_47
  v_cmp_ne_u32 vcc, s49, v7
  s_cbranch_vccnz L_pl_46
L_pd_47:
  s_add_u32 s76, s76, 32768
  s_add_u32 s57, s75, 114688
  buffer_load_dwordx4 a[28:31], v126, s[40:43], s57 offen offset:0 sc1
  s_add_u32 s57, s75, 114688
  buffer_load_dwordx4 a[32:35], v126, s[40:43], s57 offen offset:2048 sc1
  s_add_u32 s57, s75, 118784
  buffer_load_dwordx4 a[36:39], v126, s[40:43], s57 offen offset:0 sc1
  s_add_u32 s57, s75, 118784
  buffer_load_dwordx4 a[40:43], v126, s[40:43], s57 offen offset:2048 sc1
  s_add_u32 s57, s75, 122880
  buffer_load_dwordx4 a[44:47], v126, s[40:43], s57 offen offset:0 sc1
  s_add_u32 s57, s75, 122880
  buffer_load_dwordx4 a[48:51], v126, s[40:43], s57 offen offset:2048 sc1
  s_add_u32 s57, s75, 126976
  buffer_load_dwordx4 a[52:55], v126, s[40:43], s57 offen offset:0 sc1
L_gu_j:
  s_waitcnt vmcnt(7) lgkmcnt(0)
  buffer_load_dword v7, v3, s[40:43], s76 offen sc1
  v_mfma_f32_16x16x32_bf16 v[32:35], a[64:67], a[0:3], 0
  v_mfma_f32_16x16x32_bf16 v[36:39], a[68:71], a[0:3], 0
  v_mfma_f32_16x16x32_bf16 v[40:43], a[72:75], a[0:3], 0
  v_mfma_f32_16x16x32_bf16 v[44:47], a[76:79], a[0:3], 0
  v_lshrrev_b32 v0, 4, v1
  v_lshrrev_b32 v2, 4, v0
  v_and_b32 v4, 15, v0
  v_mfma_f32_16x16x32_bf16 v[32:35], a[80:83], a[4:7], v[32:35]
  v_mfma_f32_16x16x32_bf16 v[36:39], a[84:87], a[4:7], v[36:39]
  v_mfma_f32_16x16x32_bf16 v[40:43], a[88:91], a[4:7], v[40:43]
  v_mfma_f32_16x16x32_bf16 v[44:47], a[92:95], a[4:7], v[44:47]
  v_xor_b32 v6, v4, v2
  v_lshlrev_b32 v6, 4, v6
  v_lshl_add_u32 v6, v2, 8, v6
  v_mfma_f32_16x16x32_bf16 v[32:35], a[96:99], a[8:11], v[32:35]
  v_mfma_f32_16x16x32_bf16 v[36:39], a[100:103], a[8:11], v[36:39]
  v_mfma_f32_16x16x32_bf16 v[40:43], a[104:107], a[8:11], v[40:43]
  v_mfma_f32_16x16x32_bf16 v[44:47], a[108:111], a[8:11], v[44:47]
  v_add_u32 v6, s83, v6
  v_add_u32 v2, s99, v2
  v_lshlrev_b32 v5, 10, v2
  v_mfma_f32_16x16x32_bf16 v[32:35], a[112:115], a[12:15], v[32:35]
  v_mfma_f32_16x16x32_bf16 v[36:39], a[116:119], a[12:15], v[36:39]
  v_mfma_f32_16x16x32_bf16 v[40:43], a[120:123], a[12:15], v[40:43]
  v_mfma_f32_16x16x32_bf16 v[44:47], a[124:127], a[12:15], v[44:47]
  v_lshl_add_u32 v5, v4, 3, v5
  v_xor_b32 v2, v2, v4
  v_and_b32 v2, 15, v2
  v_mfma_f32_16x16x32_bf16 v[32:35], v[8:11], a[16:19], v[32:35]
  v_mfma_f32_16x16x32_bf16 v[36:39], v[12:15], a[16:19], v[36:39]
  v_mfma_f32_16x16x32_bf16 v[40:43], v[16:19], a[16:19], v[40:43]
  v_mfma_f32_16x16x32_bf16 v[44:47], v[20:23], a[16:19], v[44:47]
  v_lshlrev_b32 v2, 4, v2
  v_lshl_add_u32 v2, v4, 8, v2
  s_lshr_b32 s56, s44, 2
  s_waitcnt vmcnt(0)
  v_cmp_ne_u32 vcc, s49, v7
  s_cbranch_vccz L_ok_48
  s_mov_b32 s58, 0x80000
L_pl_49:
  buffer_load_dword v7, v3, s[40:43], s76 offen sc1
  s_waitcnt vmcnt(0)
  s_sub_u32 s58, s58, 1
  s_cmp_eq_u32 s58, 0
  s_cbranch_scc1 L_pd_50
  v_cmp_ne_u32 vcc, s49, v7
  s_cbranch_vccnz L_pl_49
L_pd_50:
L_ok_48:
  s_add_u32 s76, s76, 32768
  s_cmp_eq_u32 s44, 7
  s_cbranch_scc1 L_f3_skip
  v_mov_b32 v124, s49
  s_add_u32 s59, s67, 163840
  s_mov_b64 exec, 1
  s_cmp_eq_u32 s64, 0
  s_cbranch_scc1 L_sl_51
  buffer_store_dword v124, off, s[40:43], s59
L_sj_52:
  s_mov_b64 exec, -1
L_f3_skip:
  s_add_u32 s57, s97, 2097152
  buffer_load_dwordx4 a[56:59], v126, s[40:43], s57 offen offset:0 sc1
  v_mfma_f32_16x16x32_bf16 v[32:35], v[24:27], a[20:23], v[32:35]
  v_mfma_f32_16x16x32_bf16 v[36:39], v[28:31], a[20:23], v[36:39]
  v_mfma_f32_16x16x32_bf16 v[40:43], v[96:99], a[20:23], v[40:43]
  v_mfma_f32_16x16x32_bf16 v[44:47], v[100:103], a[20:23], v[44:47]
  s_lshl_b32 s56, s56, 15
  v_add_u32 v2, s56, v2
  v_add_u32 v4, 0x10000, v2
  s_add_u32 s57, s97, 2097152
  buffer_load_dwordx4 a[60:63], v126, s[40:43], s57 offen offset:2048 sc1
  v_mfma_f32_16x16x32_bf16 v[32:35], v[116:119], a[24:27], v[32:35]
  v_mfma_f32_16x16x32_bf16 v[36:39], v[120:123], a[24:27], v[36:39]
  v_mfma_f32_16x16x32_bf16 v[40:43], v[104:107], a[24:27], v[40:43]
  v_mfma_f32_16x16x32_bf16 v[44:47], v[108:111], a[24:27], v[44:47]
  s_lshl_b32 s56, s48, 7
  s_add_u32 s54, s100, s56
  s_add_u32 s55, s54, 65536
  s_add_u32 s57, s97, 2101248
  buffer_load_dwordx4 v[64:67], v126, s[40:43], s57 offen offset:0 sc1
  v_mfma_f32_16x16x32_bf16 v[48:51], a[64:67], a[28:31], 0
  v_mfma_f32_16x16x32_bf16 v[52:55], a[68:71], a[28:31], 0
  v_mfma_f32_16x16x32_bf16 v[56:59], a[72:75], a[28:31], 0
  v_mfma_f32_16x16x32_bf16 v[60:63], a[76:79], a[28:31], 0
  s_add_u32 s57, s97, 2101248
  buffer_load_dwordx4 v[68:71], v126, s[40:43], s57 offen offset:2048 sc1
  v_mfma_f32_16x16x32_bf16 v[48:51], a[80:83], a[32:35], v[48:51]
  v_mfma_f32_16x16x32_bf16 v[52:55], a[84:87], a[32:35], v[52:55]
  v_mfma_f32_16x16x32_bf16 v[56:59], a[88:91], a[32:35], v[56:59]
  v_mfma_f32_16x16x32_bf16 v[60:63], a[92:95], a[32:35], v[60:63]
  s_add_u32 s57, s97, 2105344
  buffer_load_dwordx4 v[72:75], v126, s[40:43], s57 offen offset:0 sc1
  v_mfma_f32_16x16x32_bf16 v[48:51], a[96:99], a[36:39], v[48:51]
  v_mfma_f32_16x16x32_bf16 v[52:55], a[100:103], a[36:39], v[52:55]
  v_mfma_f32_16x16x32_bf16 v[56:59], a[104:107], a[36:39], v[56:59]
  v_mfma_f32_16x16x32_bf16 v[60:63], a[108:111], a[36:39], v[60:63]
  v_xor_b32 v124, 0x0, v6
  ds_write_b128 v124, v[32:35] offset:0
  s_add_u32 s57, s97, 2105344
  buffer_load_dwordx4 v[76:79], v126, s[40:43], s57 offen offset:2048 sc1
  v_mfma_f32_16x16x32_bf16 v[48:51], a[112:115], a[40:43], v[48:51]
  v_mfma_f32_16x16x32_bf16 v[52:55], a[116:119], a[40:43], v[52:55]
  v_mfma_f32_16x16x32_bf16 v[56:59], a[120:123], a[40:43], v[56:59]
  v_mfma_f32_16x16x32_bf16 v[60:63], a[124:127], a[40:43], v[60:63]
  v_xor_b32 v125, 0x40, v6
  ds_write_b128 v125, v[36:39] offset:1024
  s_add_u32 s57, s97, 2109440
  buffer_load_dwordx4 v[92:95], v126, s[40:43], s57 offen offset:0 sc1
  v_mfma_f32_16x16x32_bf16 v[48:51], v[8:11], a[44:47], v[48:51]
  v_mfma_f32_16x16x32_bf16 v[52:55], v[12:15], a[44:47], v[52:55]
  v_mfma_f32_16x16x32_bf16 v[56:59], v[16:19], a[44:47], v[56:59]
  v_mfma_f32_16x16x32_bf16 v[60:63], v[20:23], a[44:47], v[60:63]
  v_xor_b32 v124, 0x80, v6
  ds_write_b128 v124, v[40:43] offset:2048
  buffer_load_dword v7, v3, s[40:43], s76 offen sc1
  v_mfma_f32_16x16x32_bf16 v[48:51], v[24:27], a[48:51], v[48:51]
  v_mfma_f32_16x16x32_bf16 v[52:55], v[28:31], a[48:51], v[52:55]
  v_mfma_f32_16x16x32_bf16 v[56:59], v[96:99], a[48:51], v[56:59]
  v_mfma_f32_16x16x32_bf16 v[60:63], v[100:103], a[48:51], v[60:63]
  v_xor_b32 v125, 0xc0, v6
  ds_write_b128 v125, v[44:47] offset:3072
  v_mfma_f32_16x16x32_bf16 v[48:51], v[116:119], a[52:55], v[48:51]
  v_mfma_f32_16x16x32_bf16 v[52:55], v[120:123], a[52:55], v[52:55]
  v_mfma_f32_16x16x32_bf16 v[56:59], v[104:107], a[52:55], v[56:59]
  v_mfma_f32_16x16x32_bf16 v[60:63], v[108:111], a[52:55], v[60:63]
  s_waitcnt vmcnt(0)
  v_cmp_ne_u32 vcc, s49, v7
  s_cbranch_vccz L_ok_53
  s_mov_b32 s58, 0x80000
L_pl_54:
  buffer_load_dword v7, v3, s[40:43], s76 offen sc1
  s_waitcnt vmcnt(0)
  s_sub_u32 s58, s58, 1
  s_cmp_eq_u32 s58, 0
  s_cbranch_scc1 L_pd_55
  v_cmp_ne_u32 vcc, s49, v7
  s_cbranch_vccnz L_pl_54
L_pd_55:
L_ok_53:
  s_add_u32 s76, s76, 32768
  s_add_u32 s57, s97, 0
  buffer_load_dwordx4 a[28:31], v126, s[40:43], s57 offen offset:0 sc1
  v_mfma_f32_16x16x32_bf16 a[0:3], a[64:67], a[56:59], 0
  v_mfma_f32_16x16x32_bf16 a[4:7], a[68:71], a[56:59], 0
  v_mfma_f32_16x16x32_bf16 a[8:11], a[72:75], a[56:59], 0
  v_mfma_f32_16x16x32_bf16 a[12:15], a[76:79], a[56:59], 0
  v_xor_b32 v124, 0x0, v6
  ds_write_b128 v124, v[48:51] offset:32768
  s_add_u32 s57, s97, 0
  buffer_load_dwordx4 a[32:35], v126, s[40:43], s57 offen offset:2048 sc1
  v_mfma_f32_16x16x32_bf16 a[0:3], a[80:83], a[60:63], a[0:3]
  v_mfma_f32_16x16x32_bf16 a[4:7], a[84:87], a[60:63], a[4:7]
  v_mfma_f32_16x16x32_bf16 a[8:11], a[88:91], a[60:63], a[8:11]
  v_mfma_f32_16x16x32_bf16 a[12:15], a[92:95], a[60:63], a[12:15]
  v_xor_b32 v125, 0x40, v6
  ds_write_b128 v125, v[52:55] offset:33792
  s_add_u32 s57, s97, 4096
  buffer_load_dwordx4 a[36:39], v126, s[40:43], s57 offen offset:0 sc1
  v_mfma_f32_16x16x32_bf16 a[0:3], a[96:99], v[64:67], a[0:3]
  v_mfma_f32_16x16x32_bf16 a[4:7], a[100:103], v[64:67], a[4:7]
  v_mfma_f32_16x16x32_bf16 a[8:11], a[104:107], v[64:67], a[8:11]
  v_mfma_f32_16x16x32_bf16 a[12:15], a[108:111], v[64:67], a[12:15]
  v_xor_b32 v124, 0x80, v6
  ds_write_b128 v124, v[56:59] offset:34816
  s_add_u32 s57, s97, 4096
  buffer_load_dwordx4 a[40:43], v126, s[40:43], s57 offen offset:2048 sc1
  v_mfma_f32_16x16x32_bf16 a[0:3], a[112:115], v[68:71], a[0:3]
  v_mfma_f32_16x16x32_bf16 a[4:7], a[116:119], v[68:71], a[4:7]
  v_mfma_f32_16x16x32_bf16 a[8:11], a[120:123], v[68:71], a[8:11]
  v_mfma_f32_16x16x32_bf16 a[12:15], a[124:127], v[68:71], a[12:15]
  v_xor_b32 v125, 0xc0, v6
  ds_write_b128 v125, v[60:63] offset:35840
  s_add_u32 s57, s97, 8192
  buffer_load_dwordx4 a[44:47], v126, s[40:43], s57 offen offset:0 sc1
  v_mfma_f32_16x16x32_bf16 a[0:3], v[8:11], v[72:75], a[0:3]
  v_mfma_f32_16x16x32_bf16 a[4:7], v[12:15], v[72:75], a[4:7]
  v_mfma_f32_16x16x32_bf16 a[8:11], v[16:19], v[72:75], a[8:11]
  v_mfma_f32_16x16x32_bf16 a[12:15], v[20:23], v[72:75], a[12:15]
  s_add_u32 s57, s97, 8192
  buffer_load_dwordx4 a[48:51], v126, s[40:43], s57 offen offset:2048 sc1
  v_mfma_f32_16x16x32_bf16 a[0:3], v[24:27], v[76:79], a[0:3]
  v_mfma_f32_16x16x32_bf16 a[4:7], v[28:31], v[76:79], a[4:7]
  v_mfma_f32_16x16x32_bf16 a[8:11], v[96:99], v[76:79], a[8:11]
  v_mfma_f32_16x16x32_bf16 a[12:15], v[100:103], v[76:79], a[12:15]
  s_add_u32 s57, s97, 12288
  buffer_load_dwordx4 a[52:55], v126, s[40:43], s57 offen offset:0 sc1
  v_mfma_f32_16x16x32_bf16 a[0:3], v[116:119], v[92:95], a[0:3]
  v_mfma_f32_16x16x32_bf16 a[4:7], v[120:123], v[92:95], a[4:7]
  v_mfma_f32_16x16x32_bf16 a[8:11], v[104:107], v[92:95], a[8:11]
  v_mfma_f32_16x16x32_bf16 a[12:15], v[108:111], v[92:95], a[12:15]
  s_waitcnt lgkmcnt(0)
  s_barrier
  ds_read_b128 v[32:35], v2 offset:0
  ds_read_b128 v[36:39], v2 offset:4096
  ds_read_b128 v[40:43], v2 offset:8192
  ds_read_b128 v[44:47], v2 offset:12288
  ds_read_b128 v[48:51], v2 offset:16384
  ds_read_b128 v[52:55], v2 offset:20480
  ds_read_b128 v[56:59], v2 offset:24576
  ds_read_b128 v[60:63], v2 offset:28672
  v_xor_b32 v124, 0x10000, v6
  ds_write_b128 v124, a[0:3] offset:0
  v_xor_b32 v125, 0x10040, v6
  ds_write_b128 v125, a[4:7] offset:1024
  v_xor_b32 v124, 0x10080, v6
  ds_write_b128 v124, a[8:11] offset:2048
  v_xor_b32 v125, 0x100c0, v6
  ds_write_b128 v125, a[12:15] offset:3072
  s_waitcnt vmcnt(6)
  v_mfma_f32_16x16x32_bf16 v[80:83], a[64:67], a[28:31], 0
  v_mfma_f32_16x16x32_bf16 v[84:87], a[68:71], a[28:31], 0
  v_mfma_f32_16x16x32_bf16 v[88:91], a[72:75], a[28:31], 0
  v_lshlrev_b32 v124, 16, v112
  v_and_b32 v125, s61, v112
  v_mfma_f32_16x16x32_bf16 v[92:95], a[76:79], a[28:31], 0
  v_lshlrev_b32 v112, 16, v113
  v_and_b32 v113, s61, v113
  s_waitcnt vmcnt(5)
  v_mfma_f32_16x16x32_bf16 v[80:83], a[80:83], a[32:35], v[80:83]
  s_waitcnt lgkmcnt(11)
  v_add_f32 v124, v124, v32
  v_mfma_f32_16x16x32_bf16 v[84:87], a[84:87], a[32:35], v[84:87]
  v_add_f32 v125, v125, v33
  v_add_f32 v112, v112, v34
  v_mfma_f32_16x16x32_bf16 v[88:91], a[88:91], a[32:35], v[88:91]
  v_add_f32 v113, v113, v35
  s_waitcnt lgkmcnt(10)
  v_mfma_f32_16x16x32_bf16 v[92:95], a[92:95], a[32:35], v[92:95]
  v_add_f32 v124, v124, v36
  v_add_f32 v125, v125, v37
  s_waitcnt vmcnt(4)
  v_mfma_f32_16x16x32_bf16 v[80:83], a[96:99], a[36:39], v[80:83]
  v_add_f32 v112, v112, v38
  v_add_f32 v113, v113, v39
  v_mfma_f32_16x16x32_bf16 v[84:87], a[100:103], a[36:39], v[84:87]
  s_waitcnt lgkmcnt(9)
  v_add_f32 v124, v124, v40
  v_mfma_f32_16x16x32_bf16 v[88:91], a[104:107], a[36:39], v[88:91]
  v_add_f32 v125, v125, v41
  v_add_f32 v112, v112, v42
  v_mfma_f32_16x16x32_bf16 v[92:95], a[108:111], a[36:39], v[92:95]
  v_add_f32 v113, v113, v43
  s_waitcnt lgkmcnt(8) vmcnt(3)
  v_mfma_f32_16x16x32_bf16 v[80:83], a[112:115], a[40:43], v[80:83]
  v_add_f32 v124, v124, v44
  v_add_f32 v125, v125, v45
  v_mfma_f32_16x16x32_bf16 v[84:87], a[116:119], a[40:43], v[84:87]
  v_add_f32 v112, v112, v46
  v_add_f32 v113, v113, v47
  v_mfma_f32_16x16x32_bf16 v[88:91], a[120:123], a[40:43], v[88:91]
  s_waitcnt lgkmcnt(7)
  v_add_f32 v124, v124, v48
  v_mfma_f32_16x16x32_bf16 v[92:95], a[124:127], a[40:43], v[92:95]
  v_add_f32 v125, v125, v49
  v_add_f32 v112, v112, v50
  s_waitcnt vmcnt(2)
  v_mfma_f32_16x16x32_bf16 v[80:83], v[8:11], a[44:47], v[80:83]
  v_add_f32 v113, v113, v51
  s_waitcnt lgkmcnt(6)
  v_mfma_f32_16x16x32_bf16 v[84:87], v[12:15], a[44:47], v[84:87]
  v_add_f32 v124, v124, v52
  v_add_f32 v125, v125, v53
  v_mfma_f32_16x16x32_bf16 v[88:91], v[16:19], a[44:47], v[88:91]
  v_add_f32 v112, v112, v54
  v_add_f32 v113, v113, v55
  v_mfma_f32_16x16x32_bf16 v[92:95], v[20:23], a[44:47], v[92:95]
  s_waitcnt lgkmcnt(5)
  v_add_f32 v124, v124, v56
  s_waitcnt vmcnt(1)
  v_mfma_f32_16x16x32_bf16 v[80:83], v[24:27], a[48:51], v[80:83]
  v_add_f32 v125, v125, v57
  v_add_f32 v112, v112, v58
  v_mfma_f32_16x16x32_bf16 v[84:87], v[28:31], a[48:51], v[84:87]
  v_add_f32 v113, v113, v59
  s_waitcnt lgkmcnt(4)
  v_mfma_f32_16x16x32_bf16 v[88:91], v[96:99], a[48:51], v[88:91]
  v_add_f32 v124, v124, v60
  v_add_f32 v125, v125, v61
  v_mfma_f32_16x16x32_bf16 v[92:95], v[100:103], a[48:51], v[92:95]
  v_add_f32 v112, v112, v62
  v_add_f32 v113, v113, v63
  s_waitcnt vmcnt(0)
  v_mfma_f32_16x16x32_bf16 v[80:83], v[116:119], a[52:55], v[80:83]
  v_cvt_pk_bf16_f32 v124, v124, v125
  v_cvt_pk_bf16_f32 v125, v112, v113
  v_mfma_f32_16x16x32_bf16 v[84:87], v[120:123], a[52:55], v[84:87]
  buffer_store_dwordx2 v[124:125], v5, s[36:39], s54 offen sc1
  v_mfma_f32_16x16x32_bf16 v[88:91], v[104:107], a[52:55], v[88:91]
  v_mfma_f32_16x16x32_bf16 v[92:95], v[108:111], a[52:55], v[92:95]
  s_cmp_lg_u32 s3, 0
  s_cbranch_scc1 L_wbe
  s_cmp_lg_u32 s44, 0
  s_cbranch_scc1 L_wbe
  buffer_wbl2 sc1
L_wbe:
  v_xor_b32 v8, 0x10000, v6
  v_xor_b32 v9, 0x10040, v6
  v_xor_b32 v10, 0x10080, v6
  v_xor_b32 v11, 0x100c0, v6
  v_lshlrev_b32 v12, 16, v114
  v_and_b32 v13, s61, v114
  v_lshlrev_b32 v14, 16, v115
  v_and_b32 v15, s61, v115
  ds_write_b128 v8, v[80:83] offset:32768
  ds_write_b128 v9, v[84:87] offset:33792
  ds_write_b128 v10, v[88:91] offset:34816
  ds_write_b128 v11, v[92:95] offset:35840
  s_waitcnt lgkmcnt(0)
  s_barrier
  ds_read_b128 v[32:35], v4 offset:0
  ds_read_b128 v[36:39], v4 offset:4096
  ds_read_b128 v[40:43], v4 offset:8192
  ds_read_b128 v[44:47], v4 offset:12288
  ds_read_b128 v[48:51], v4 offset:16384
  ds_read_b128 v[52:55], v4 offset:20480
  ds_read_b128 v[56:59], v4 offset:24576
  ds_read_b128 v[60:63], v4 offset:28672
  s_waitcnt lgkmcnt(6)
  v_pk_add_f32 v[32:33], v[32:33], v[36:37]
  v_pk_add_f32 v[34:35], v[34:35], v[38:39]
  v_pk_add_f32 v[12:13], v[12:13], v[32:33]
  v_pk_add_f32 v[14:15], v[14:15], v[34:35]
  s_waitcnt lgkmcnt(4)
  v_pk_add_f32 v[40:41], v[40:41], v[44:45]
  v_pk_add_f32 v[42:43], v[42:43], v[46:47]
  v_pk_add_f32 v[12:13], v[12:13], v[40:41]
  v_pk_add_f32 v[14:15], v[14:15], v[42:43]
  s_waitcnt lgkmcnt(2)
  v_pk_add_f32 v[48:49], v[48:49], v[52:53]
  v_pk_add_f32 v[50:51], v[50:51], v[54:55]
  v_pk_add_f32 v[12:13], v[12:13], v[48:49]
  v_pk_add_f32 v[14:15], v[14:15], v[50:51]
  s_waitcnt lgkmcnt(0)
  v_pk_add_f32 v[56:57], v[56:57], v[60:61]
  v_pk_add_f32 v[58:59], v[58:59], v[62:63]
  v_pk_add_f32 v[12:13], v[12:13], v[56:57]
  v_pk_add_f32 v[14:15], v[14:15], v[58:59]
  v_cvt_pk_bf16_f32 v12, v12, v13
  v_cvt_pk_bf16_f32 v13, v14, v15
  buffer_store_dwordx2 v[12:13], v5, s[36:39], s55 offen
L_exit:
  s_endpgm
L_pr_1:
  s_mov_b32 s58, 0x80000
L_pl_3:
  buffer_load_dword v20, v126, s[40:43], s57 offen sc1
  s_waitcnt vmcnt(0)
  v_cmp_ne_u32 vcc, s49, v20
  s_cbranch_vccz L_pj_2
  s_sub_u32 s58, s58, 1
  s_cmp_eq_u32 s58, 0
  s_cbranch_scc1 L_pj_2
  s_branch L_pl_3
L_tp1_retry:
  s_mov_b32 s58, 0x80000
L_tp1_loop:
  s_sleep 2
  buffer_load_dwordx4 v[28:31], v7, s[40:43], s59 offen sc1
  s_waitcnt vmcnt(0)
  v_xor_b32 v28, s49, v28
  v_xor_b32 v29, s49, v29
  v_xor_b32 v30, s49, v30
  v_xor_b32 v31, s49, v31
  v_or_b32 v28, v28, v29
  v_or3_b32 v28, v28, v30, v31
  v_cmp_ne_u32 vcc, 0, v28
  s_cbranch_vccz L_tp1_ok
  s_sub_u32 s58, s58, 1
  s_cmp_eq_u32 s58, 0
  s_cbranch_scc0 L_tp1_loop
  s_branch L_tp1_ok
L_sl_12:
  buffer_store_dwordx4 v[36:39], v1, s[40:43], s56 offen sc1
  s_branch L_sj_13
L_fb:
  s_waitcnt vmcnt(0) lgkmcnt(0)
  v_mov_b32 v48, 0xff800000
  s_mov_b32 s57, 1048576
L_fb1:
  buffer_load_dwordx4 v[88:91], v1, s[40:43], s57 offen sc1
  s_waitcnt vmcnt(0)
  v_mfma_f32_32x32x16_bf16 v[32:47], v[88:91], v[112:115], 0
  s_add_u32 s57, s57, 1024
  s_nop 15
  v_max3_f32 v48, v48, v32, v33
  v_max3_f32 v48, v48, v34, v35
  v_max3_f32 v48, v48, v36, v37
  v_max3_f32 v48, v48, v38, v39
  v_max3_f32 v48, v48, v40, v41
  v_max3_f32 v48, v48, v42, v43
  v_max3_f32 v48, v48, v44, v45
  v_max3_f32 v48, v48, v46, v47
  s_cmp_lt_u32 s57, 1114112
  s_cbranch_scc1 L_fb1
  v_mov_b32 v49, v48
  s_nop 1
  v_permlane32_swap_b32 v48, v49
  s_nop 1
  v_max_f32 v48, v48, v49
  v_sub_f32 v48, 0, v48
  v_mov_b32 v49, v48
  v_mov_b32 v50, v48
  v_mov_b32 v51, v48
  v_mov_b32 v52, v48
  v_mov_b32 v53, v48
  v_mov_b32 v54, v48
  v_mov_b32 v55, v48
  v_mov_b32 v56, v48
  v_mov_b32 v57, v48
  v_mov_b32 v58, v48
  v_mov_b32 v59, v48
  v_mov_b32 v60, v48
  v_mov_b32 v61, v48
  v_mov_b32 v62, v48
  v_mov_b32 v63, v48
  v_mov_b32 v72, 0
  v_mov_b32 v73, 0
  v_mov_b32 v74, 0
  v_mov_b32 v75, 0
  v_mov_b32 v76, 0
  v_mov_b32 v77, 0
  v_mov_b32 v78, 0
  v_mov_b32 v79, 0
  v_mov_b32 v80, 0
  v_mov_b32 v81, 0
  v_mov_b32 v82, 0
  v_mov_b32 v83, 0
  v_mov_b32 v84, 0
  v_mov_b32 v85, 0
  v_mov_b32 v86, 0
  v_mov_b32 v87, 0
  v_subrev_u32 v92, 67072, v3
  v_mov_b32 v93, s60
  s_mov_b32 vcc_lo, 0x10010000
  s_mov_b32 vcc_hi, 0x10010000
  v_cndmask_b32 v96, 0, v93, vcc
  v_mov_b32 v97, v96
  v_mov_b32 v98, v96
  v_mov_b32 v99, v96
  v_mov_b32 v100, v96
  v_mov_b32 v101, v96
  v_mov_b32 v102, v96
  v_mov_b32 v103, v96
  s_mov_b32 s57, 1048576
  s_mov_b32 s58, 1114112
L_fb2:
  buffer_load_dwordx4 v[88:91], v1, s[40:43], s57 offen sc1
  s_mov_b32 exec_lo, 0xffff
  s_mov_b32 exec_hi, 0xffff
  buffer_load_dwordx4 v[96:99], v92, s[40:43], s58 offen sc1
  buffer_load_dwordx4 v[100:103], v92, s[40:43], s58 offen offset:512 sc1
  s_mov_b64 exec, -1
  s_waitcnt vmcnt(0)
  v_mfma_f32_32x32x16_bf16 v[32:47], v[88:91], v[112:115], v[48:63]
  s_add_u32 s57, s57, 1024
  s_add_u32 s58, s58, 1024
  s_nop 15
  v_exp_f32 v32, v32
  v_exp_f32 v33, v33
  v_exp_f32 v34, v34
  v_exp_f32 v35, v35
  v_exp_f32 v36, v36
  v_exp_f32 v37, v37
  v_exp_f32 v38, v38
  v_exp_f32 v39, v39
  v_exp_f32 v40, v40
  v_exp_f32 v41, v41
  v_exp_f32 v42, v42
  v_exp_f32 v43, v43
  v_exp_f32 v44, v44
  v_exp_f32 v45, v45
  v_exp_f32 v46, v46
  v_exp_f32 v47, v47
  s_nop 1
  v_smfmac_f32_32x32x32_bf16 v[72:87], v[96:99], v[32:39], v64
  v_smfmac_f32_32x32x32_bf16 v[72:87], v[100:103], v[40:47], v64
  s_cmp_lt_u32 s57, 1114112
  s_nop 7
  s_cbranch_scc1 L_fb2
  s_nop 15
  v_add_f32 v80, v80, v84
  s_branch L_fb_done
L_sl_14:
  buffer_store_dword v32, off, s[40:43], s59 sc1
  s_branch L_sj_15
L_sl_19:
  buffer_store_dwordx4 v[72:75], v3, s[40:43], s55 offen sc1
  s_branch L_sj_20
L_sl_21:
  buffer_store_dwordx2 v[76:77], v126, s[40:43], s62 offen sc1
  s_branch L_sj_22
L_sl_23:
  buffer_store_dword v82, off, s[40:43], s59 sc1
  s_branch L_sj_24
L_sl_28:
  buffer_store_dwordx4 v[88:91], v1, s[40:43], s56 offen sc1
  s_branch L_sj_29
L_sl_30:
  buffer_store_dword v7, off, s[40:43], s59 sc1
  s_branch L_sj_31
L_sl_32:
  buffer_store_dword v7, off, s[40:43], s59 sc1
  s_branch L_sj_33
L_sl_37:
  buffer_store_dwordx4 v[88:91], v1, s[40:43], s96 offen sc1
  s_branch L_sj_38
L_sl_42:
  buffer_store_dword v7, off, s[40:43], s59 sc1
  s_branch L_sj_43
L_sl_51:
  buffer_store_dword v124, off, s[40:43], s59 sc1
  s_branch L_sj_52
L_end:
.section .rodata,"a"
.p2align 6
.amdhsa_kernel sequential_preLN__grouped_kv_mqa__geglu_ffn__prompt_kernel
  .amdhsa_next_free_vgpr 256
  .amdhsa_next_free_sgpr 102
  .amdhsa_accum_offset 128
  .amdhsa_group_segment_fixed_size 0
  .amdhsa_kernarg_size 96
  .amdhsa_user_sgpr_count 2
  .amdhsa_user_sgpr_kernarg_segment_ptr 1
  .amdhsa_system_sgpr_workgroup_id_x 1
.end_amdhsa_kernel
```
